```python
import torch

def _softmax(x, axis=-1):
    return torch.softmax(x, dim=axis)
def _gelu(x):
    return torch.nn.functional.gelu(x, approximate="tanh")
def _silu(x):
    return torch.nn.functional.silu(x)
def _sigmoid(x):
    return torch.sigmoid(x)
def _layernorm(x, axis=-1, eps=1e-5):
    m = x.mean(dim=axis, keepdim=True)
    v = x.var(dim=axis, keepdim=True, unbiased=False)
    return (x - m) / torch.sqrt(v + eps)
def _scatter_add(tgt, idx, src, axis=0):
    return tgt.clone().index_add_(axis, idx, src)
def _segment_sum(src, seg, n):
    out = torch.zeros((n,) + src.shape[1:], dtype=src.dtype)
    return out.index_add_(0, seg, src)
def _pad(x, pw):
    flat = tuple(v for pair in reversed(pw) for v in pair)
    return torch.nn.functional.pad(x, flat)

kernel_name = 'sequential_preLN__sliding_block_cached__dense_activation_squared_relu__decode'

def setup_inputs():

    _w = (lambda a: (lambda t: t.to(torch.bfloat16) if t.is_floating_point() else t)(torch.as_tensor(a)))
    def _A_setup():
        B, Sq, D = 1, 1, 512
        Hq, Hkv, Sk, Dh = 32, 32, 32768, 128
        assert Hq % Hkv == 0, (Hq, Hkv)
        return {
            "x": _w((lambda *s: torch.randn(*s, dtype=torch.bfloat16) * 0.05)(B, Sq, D)),
            "k_cache": _w((lambda *s: torch.randn(*s, dtype=torch.bfloat16) * 3.2)(B, Hkv, Sk, Dh)),
            "v_cache": _w((lambda *s: torch.randn(*s, dtype=torch.bfloat16) * 0.4)(B, Hkv, Sk, Dh)),
            "wq": _w((lambda *s: torch.randn(*s, dtype=torch.bfloat16) * 3.2)(D, Hq * Dh) * (D ** -0.5)),
            "wo": _w((lambda *s: torch.randn(*s, dtype=torch.bfloat16) * 0.4)(Hq * Dh, D) * ((Hq * Dh) ** -0.5)),
        }
    _A_in = _A_setup()

    def _B_setup():
        B, S, D, F = 1, 1, 512, 1376
        return {
            "x": _w((lambda *s: torch.randn(*s, dtype=torch.bfloat16) * 0.05)(B, S, D)),
            "w1": _w((lambda *s: torch.randn(*s, dtype=torch.bfloat16) * 0.05)(D, F)),
            "b1": _w((lambda *s: torch.randn(*s, dtype=torch.bfloat16) * 0.8)(F)),
            "w2": _w((lambda *s: torch.randn(*s, dtype=torch.bfloat16) * 0.05)(F, D)),
            "b2": _w((lambda *s: torch.randn(*s, dtype=torch.bfloat16) * 3.2)(D)),
        }
    _B_in = _B_setup()

    return {
        "A_x": _A_in["x"],
        "A_k_cache": _A_in["k_cache"],
        "A_v_cache": _A_in["v_cache"],
        "A_wq": _A_in["wq"],
        "A_wo": _A_in["wo"],
        "B_x": _B_in["x"],
        "B_w1": _B_in["w1"],
        "B_b1": _B_in["b1"],
        "B_w2": _B_in["w2"],
        "B_b2": _B_in["b2"],
    }

def reference(A_x, A_k_cache, A_v_cache, A_wq, A_wo, B_x, B_w1, B_b1, B_w2, B_b2):
    def _A_ref(x, k_cache, v_cache, wq, wo):
        B, Sq, D = x.shape
        Hq, Dh = 32, 128
        Hkv, Sk = k_cache.shape[1], k_cache.shape[2]
        W = min(4096, max(256, Sk // 4))
        rep = Hq // Hkv
        q = (lambda x, *d: x.permute(*d))((x @ wq).reshape(B, Sq, Hq, Dh), 0, 2, 1, 3)
        k = (lambda x, n, axis: torch.repeat_interleave(x, n, dim=axis))(k_cache[:, :, Sk - W:, :], rep, axis=1)
        v = (lambda x, n, axis: torch.repeat_interleave(x, n, dim=axis))(v_cache[:, :, Sk - W:, :], rep, axis=1)
        scores = torch.einsum("bhqd,bhkd->bhqk", q, k) * (Dh ** -0.5)
        p = _softmax(scores, axis=-1)
        o = torch.einsum("bhqk,bhkd->bhqd", p, v)
        return (lambda x, *d: x.permute(*d))(o, 0, 2, 1, 3).reshape(B, Sq, Hq * Dh) @ wo

    def _B_ref(x, w1, b1, w2, b2):
        h = torch.einsum("bsd,df->bsf", x, w1) + b1
        zero = torch.zeros_like(h)
        r = torch.where(h > zero, h, zero)
        h = r * r
        out = torch.einsum("bsf,fd->bsd", h, w2) + b2
        return out

    x = A_x
    h = x + _A_ref(_layernorm(x, axis=-1), A_k_cache, A_v_cache, A_wq, A_wo)
    h2 = h + _B_ref(_layernorm(h, axis=-1), B_w1, B_b1, B_w2, B_b2)
    return h2
```

```asm
; @launch grid=(256,1,1) block=(1024,1,1) lds=95744
.amdgcn_target "amdgcn-amd-amdhsa--gfx950"
.text
.globl sequential_preLN__sliding_block_cached__dense_activation_squared_relu__decode_kernel
.p2align 8
.type sequential_preLN__sliding_block_cached__dense_activation_squared_relu__decode_kernel,@function
sequential_preLN__sliding_block_cached__dense_activation_squared_relu__decode_kernel:
    s_cmp_ge_u32 s2, 256
    s_cbranch_scc1 L_end2
    s_load_dwordx16 s[16:31], s[0:1], 0
    s_load_dwordx8 s[32:39], s[0:1], 64
    s_load_dwordx2 s[40:41], s[0:1], 96
    v_and_b32 v1, 63, v0
    v_lshrrev_b32 v4, 6, v0
    v_lshrrev_b32 v2, 4, v1
    v_and_b32 v3, 15, v1
    v_lshlrev_b32 v3, 4, v3
    v_readfirstlane_b32 s3, v4
    s_and_b32 s4, s2, 7
    s_lshr_b32 s5, s2, 3
    s_and_b32 s6, s5, 3
    s_lshr_b32 s7, s5, 2
    s_lshl_b32 s8, s4, 2
    s_add_u32 s8, s8, s6
    s_and_b32 s9, s3, 7
    s_mov_b32 s14, 0x05040100
    s_mov_b32 s15, 0x07060302
    v_lshl_add_u32 v4, v2, 12, v3
    s_lshl_b32 s54, s8, 23
    s_add_u32 s54, s54, 0x700000
    s_lshl_b32 s55, s7, 17
    s_add_u32 s54, s54, s55
    s_lshl_b32 s55, s9, 14
    s_add_u32 s54, s54, s55
    s_waitcnt lgkmcnt(0)
    s_add_u32 s74, s40, 1048576
    s_addc_u32 s75, s41, 0
    s_load_dwordx2 s[98:99], s[74:75], 0
    s_cmp_lt_u32 s3, 8
    s_cselect_b32 s42, s18, s20
    s_cselect_b32 s43, s19, s21
    s_add_u32 s42, s42, s54
    s_addc_u32 s43, s43, 0
    s_lshl_b32 s54, s2, 11
    s_add_u32 s10, s40, s54
    s_addc_u32 s11, s41, 0
    s_cmp_lt_u32 s3, 8
    s_cbranch_scc0 L_vpath
    s_barrier
    v_and_b32 v6, 31, v1
    v_lshrrev_b32 v7, 5, v1
    v_lshl_or_b32 v5, v6, 1, v7
    s_lshl_b32 s54, s9, 6
    v_add_u32 v5, s54, v5
    v_lshlrev_b32 v6, 1, v5
    global_load_ushort v56, v6, s[16:17]
    v_lshrrev_b32 v6, 1, v0
    v_lshlrev_b32 v6, 10, v6
    v_and_b32 v7, 1, v0
    v_lshl_add_u32 v6, v7, 4, v6
    s_lshl_b32 s54, s4, 19
    s_lshl_b32 s55, s5, 5
    s_add_u32 s54, s54, s55
    s_add_u32 s74, s24, s54
    s_addc_u32 s75, s25, 0
    global_load_dwordx4 v[8:11], v6, s[74:75] nt
    s_add_u32 s12, s74, 262144
    s_addc_u32 s13, s75, 0
    global_load_dwordx4 v[12:15], v6, s[12:13] nt
    s_cmp_ge_u32 s2, 43
    s_cbranch_scc1 L_tiles_issued
    v_and_b32 v7, 31, v1
    s_lshl_b32 s54, s2, 6
    v_lshl_add_u32 v7, v7, 1, s54
    global_load_ushort v57, v7, s[30:31]
    s_cmp_ge_u32 s2, 32
    s_cbranch_scc1 L_tiles_issued
    v_and_b32 v7, 15, v1
    s_lshl_b32 s54, s2, 5
    v_lshl_add_u32 v7, v7, 1, s54
    global_load_ushort v58, v7, s[34:35]
L_tiles_issued:
    s_cmp_eq_u32 s9, 7
    s_cbranch_scc0 L_pf_done
    v_mul_u32_u24 v6, 2752, v1
    v_lshlrev_b32 v7, 7, v1
    s_add_u32 s54, s5, 0
    s_mul_i32 s55, s54, 43
    s_lshr_b32 s55, s55, 9
    s_mul_i32 s57, s55, 12
    s_sub_u32 s54, s54, s57
    s_lshl_b32 s55, s55, 3
    s_add_u32 s55, s55, s4
    s_cmp_ge_u32 s55, 43
    s_cbranch_scc1 L_pf_next_1
    s_cmp_ge_u32 s54, 8
    s_cbranch_scc1 L_pf_w2_2
    s_mul_i32 s54, s54, 176128
    s_lshl_b32 s55, s55, 6
    s_add_u32 s54, s54, s55
    s_add_u32 s74, s28, s54
    s_addc_u32 s75, s29, 0
    global_load_dword v48, v6, s[74:75]
    s_branch L_pf_next_1
L_pf_w2_2:
    s_sub_u32 s54, s54, 8
    s_lshl_b32 s54, s54, 13
    s_lshl_b32 s55, s55, 15
    s_add_u32 s54, s54, s55
    s_add_u32 s74, s32, s54
    s_addc_u32 s75, s33, 0
    global_load_dword v48, v7, s[74:75]
L_pf_next_1:
    s_add_u32 s54, s5, 32
    s_mul_i32 s55, s54, 43
    s_lshr_b32 s55, s55, 9
    s_mul_i32 s57, s55, 12
    s_sub_u32 s54, s54, s57
    s_lshl_b32 s55, s55, 3
    s_add_u32 s55, s55, s4
    s_cmp_ge_u32 s55, 43
    s_cbranch_scc1 L_pf_next_3
    s_cmp_ge_u32 s54, 8
    s_cbranch_scc1 L_pf_w2_4
    s_mul_i32 s54, s54, 176128
    s_lshl_b32 s55, s55, 6
    s_add_u32 s54, s54, s55
    s_add_u32 s74, s28, s54
    s_addc_u32 s75, s29, 0
    global_load_dword v49, v6, s[74:75]
    s_branch L_pf_next_3
L_pf_w2_4:
    s_sub_u32 s54, s54, 8
    s_lshl_b32 s54, s54, 13
    s_lshl_b32 s55, s55, 15
    s_add_u32 s54, s54, s55
    s_add_u32 s74, s32, s54
    s_addc_u32 s75, s33, 0
    global_load_dword v49, v7, s[74:75]
L_pf_next_3:
    s_add_u32 s54, s5, 64
    s_mul_i32 s55, s54, 43
    s_lshr_b32 s55, s55, 9
    s_mul_i32 s57, s55, 12
    s_sub_u32 s54, s54, s57
    s_lshl_b32 s55, s55, 3
    s_add_u32 s55, s55, s4
    s_cmp_ge_u32 s55, 43
    s_cbranch_scc1 L_pf_next_5
    s_cmp_ge_u32 s54, 8
    s_cbranch_scc1 L_pf_w2_6
    s_mul_i32 s54, s54, 176128
    s_lshl_b32 s55, s55, 6
    s_add_u32 s54, s54, s55
    s_add_u32 s74, s28, s54
    s_addc_u32 s75, s29, 0
    global_load_dword v50, v6, s[74:75]
    s_branch L_pf_next_5
L_pf_w2_6:
    s_sub_u32 s54, s54, 8
    s_lshl_b32 s54, s54, 13
    s_lshl_b32 s55, s55, 15
    s_add_u32 s54, s54, s55
    s_add_u32 s74, s32, s54
    s_addc_u32 s75, s33, 0
    global_load_dword v50, v7, s[74:75]
L_pf_next_5:
L_pf_done:
    global_load_dwordx4 v[64:67], v4, s[42:43] nt
    global_load_dwordx4 v[68:71], v4, s[42:43] offset:256 nt
    global_load_dwordx4 v[72:75], v4, s[42:43] offset:512 nt
    global_load_dwordx4 v[76:79], v4, s[42:43] offset:768 nt
    global_load_dwordx4 v[80:83], v4, s[42:43] offset:1024 nt
    global_load_dwordx4 v[84:87], v4, s[42:43] offset:1280 nt
    global_load_dwordx4 v[88:91], v4, s[42:43] offset:1536 nt
    global_load_dwordx4 v[92:95], v4, s[42:43] offset:1792 nt
    global_load_dwordx4 v[96:99], v4, s[42:43] offset:2048 nt
    global_load_dwordx4 v[100:103], v4, s[42:43] offset:2304 nt
    global_load_dwordx4 v[104:107], v4, s[42:43] offset:2560 nt
    global_load_dwordx4 v[108:111], v4, s[42:43] offset:2816 nt
    global_load_dwordx4 v[112:115], v4, s[42:43] offset:3072 nt
    global_load_dwordx4 v[116:119], v4, s[42:43] offset:3328 nt
    global_load_dwordx4 v[120:123], v4, s[42:43] offset:3584 nt
    global_load_dwordx4 v[124:127], v4, s[42:43] offset:3840 nt
    v_mov_b32 v6, 0
    v_mov_b32 v7, 1
    s_mov_b64 exec, 1
    ds_add_u32 v6, v7 offset:4440
    s_mov_b64 exec, -1
    s_waitcnt vmcnt(16)
    v_lshlrev_b32 v6, 4, v0
    ds_write_b128 v6, v[8:11] offset:13824
    ds_write_b128 v6, v[12:15] offset:22016
L_tiles_done:
    s_waitcnt lgkmcnt(0)
    s_add_u32 s98, s98, 1
    s_add_u32 s99, s99, 1
    v_mov_b32 v6, 0
L_wait_q_7:
    ds_read_b32 v7, v6 offset:4436
    s_waitcnt lgkmcnt(0)
    v_readfirstlane_b32 s57, v7
    s_cmp_lt_u32 s57, 2
    s_cbranch_scc1 L_wait_q_7
    ds_read_b128 v[8:11], v3 offset:4096
    v_and_b32 v12, 8, v1
    v_cmp_ne_u32 s[46:47], 0, v12
    v_and_b32 v12, 4, v1
    v_cmp_ne_u32 s[48:49], 0, v12
    v_and_b32 v12, 2, v1
    v_cmp_ne_u32 s[50:51], 0, v12
    v_and_b32 v12, 1, v1
    v_cmp_ne_u32 s[52:53], 0, v12
    s_waitcnt lgkmcnt(0)
    s_waitcnt vmcnt(15)
    v_dot2_f32_bf16 v16, v64, v8, 0
    v_dot2_f32_bf16 v16, v65, v9, v16
    v_dot2_f32_bf16 v16, v66, v10, v16
    v_dot2_f32_bf16 v16, v67, v11, v16
    s_waitcnt vmcnt(14)
    v_dot2_f32_bf16 v17, v68, v8, 0
    v_dot2_f32_bf16 v17, v69, v9, v17
    v_dot2_f32_bf16 v17, v70, v10, v17
    v_dot2_f32_bf16 v17, v71, v11, v17
    s_waitcnt vmcnt(13)
    v_dot2_f32_bf16 v18, v72, v8, 0
    v_dot2_f32_bf16 v18, v73, v9, v18
    v_dot2_f32_bf16 v18, v74, v10, v18
    v_dot2_f32_bf16 v18, v75, v11, v18
    s_waitcnt vmcnt(12)
    v_dot2_f32_bf16 v19, v76, v8, 0
    v_dot2_f32_bf16 v19, v77, v9, v19
    v_dot2_f32_bf16 v19, v78, v10, v19
    v_dot2_f32_bf16 v19, v79, v11, v19
    s_waitcnt vmcnt(11)
    v_dot2_f32_bf16 v20, v80, v8, 0
    v_dot2_f32_bf16 v20, v81, v9, v20
    v_dot2_f32_bf16 v20, v82, v10, v20
    v_dot2_f32_bf16 v20, v83, v11, v20
    s_waitcnt vmcnt(10)
    v_dot2_f32_bf16 v21, v84, v8, 0
    v_dot2_f32_bf16 v21, v85, v9, v21
    v_dot2_f32_bf16 v21, v86, v10, v21
    v_dot2_f32_bf16 v21, v87, v11, v21
    s_waitcnt vmcnt(9)
    v_dot2_f32_bf16 v22, v88, v8, 0
    v_dot2_f32_bf16 v22, v89, v9, v22
    v_dot2_f32_bf16 v22, v90, v10, v22
    v_dot2_f32_bf16 v22, v91, v11, v22
    s_waitcnt vmcnt(8)
    v_dot2_f32_bf16 v23, v92, v8, 0
    v_dot2_f32_bf16 v23, v93, v9, v23
    v_dot2_f32_bf16 v23, v94, v10, v23
    v_dot2_f32_bf16 v23, v95, v11, v23
    s_waitcnt vmcnt(7)
    v_dot2_f32_bf16 v24, v96, v8, 0
    v_dot2_f32_bf16 v24, v97, v9, v24
    v_dot2_f32_bf16 v24, v98, v10, v24
    v_dot2_f32_bf16 v24, v99, v11, v24
    s_waitcnt vmcnt(6)
    v_dot2_f32_bf16 v25, v100, v8, 0
    v_dot2_f32_bf16 v25, v101, v9, v25
    v_dot2_f32_bf16 v25, v102, v10, v25
    v_dot2_f32_bf16 v25, v103, v11, v25
    s_waitcnt vmcnt(5)
    v_dot2_f32_bf16 v26, v104, v8, 0
    v_dot2_f32_bf16 v26, v105, v9, v26
    v_dot2_f32_bf16 v26, v106, v10, v26
    v_dot2_f32_bf16 v26, v107, v11, v26
    s_waitcnt vmcnt(4)
    v_dot2_f32_bf16 v27, v108, v8, 0
    v_dot2_f32_bf16 v27, v109, v9, v27
    v_dot2_f32_bf16 v27, v110, v10, v27
    v_dot2_f32_bf16 v27, v111, v11, v27
    s_waitcnt vmcnt(3)
    v_dot2_f32_bf16 v28, v112, v8, 0
    v_dot2_f32_bf16 v28, v113, v9, v28
    v_dot2_f32_bf16 v28, v114, v10, v28
    v_dot2_f32_bf16 v28, v115, v11, v28
    s_waitcnt vmcnt(2)
    v_dot2_f32_bf16 v29, v116, v8, 0
    v_dot2_f32_bf16 v29, v117, v9, v29
    v_dot2_f32_bf16 v29, v118, v10, v29
    v_dot2_f32_bf16 v29, v119, v11, v29
    s_waitcnt vmcnt(1)
    v_dot2_f32_bf16 v30, v120, v8, 0
    v_dot2_f32_bf16 v30, v121, v9, v30
    v_dot2_f32_bf16 v30, v122, v10, v30
    v_dot2_f32_bf16 v30, v123, v11, v30
    s_waitcnt vmcnt(0)
    v_dot2_f32_bf16 v31, v124, v8, 0
    v_dot2_f32_bf16 v31, v125, v9, v31
    v_dot2_f32_bf16 v31, v126, v10, v31
    v_dot2_f32_bf16 v31, v127, v11, v31
    v_cndmask_b32 v32, v24, v16, s[46:47]
    v_cndmask_b32 v33, v25, v17, s[46:47]
    v_cndmask_b32 v34, v26, v18, s[46:47]
    v_cndmask_b32 v35, v27, v19, s[46:47]
    v_cndmask_b32 v36, v28, v20, s[46:47]
    v_cndmask_b32 v37, v29, v21, s[46:47]
    v_cndmask_b32 v38, v30, v22, s[46:47]
    v_cndmask_b32 v39, v31, v23, s[46:47]
    v_cndmask_b32 v16, v16, v24, s[46:47]
    v_cndmask_b32 v17, v17, v25, s[46:47]
    v_cndmask_b32 v18, v18, v26, s[46:47]
    v_cndmask_b32 v19, v19, v27, s[46:47]
    v_cndmask_b32 v20, v20, v28, s[46:47]
    v_cndmask_b32 v21, v21, v29, s[46:47]
    v_cndmask_b32 v22, v22, v30, s[46:47]
    v_cndmask_b32 v23, v23, v31, s[46:47]
    v_add_f32_dpp v16, v32, v16 row_mirror row_mask:0xf bank_mask:0xf
    v_add_f32_dpp v17, v33, v17 row_mirror row_mask:0xf bank_mask:0xf
    v_add_f32_dpp v18, v34, v18 row_mirror row_mask:0xf bank_mask:0xf
    v_add_f32_dpp v19, v35, v19 row_mirror row_mask:0xf bank_mask:0xf
    v_add_f32_dpp v20, v36, v20 row_mirror row_mask:0xf bank_mask:0xf
    v_add_f32_dpp v21, v37, v21 row_mirror row_mask:0xf bank_mask:0xf
    v_add_f32_dpp v22, v38, v22 row_mirror row_mask:0xf bank_mask:0xf
    v_add_f32_dpp v23, v39, v23 row_mirror row_mask:0xf bank_mask:0xf
    v_cndmask_b32 v32, v20, v16, s[48:49]
    v_cndmask_b32 v33, v21, v17, s[48:49]
    v_cndmask_b32 v34, v22, v18, s[48:49]
    v_cndmask_b32 v35, v23, v19, s[48:49]
    v_cndmask_b32 v16, v16, v20, s[48:49]
    v_cndmask_b32 v17, v17, v21, s[48:49]
    v_cndmask_b32 v18, v18, v22, s[48:49]
    v_cndmask_b32 v19, v19, v23, s[48:49]
    v_add_f32_dpp v16, v32, v16 row_half_mirror row_mask:0xf bank_mask:0xf
    v_add_f32_dpp v17, v33, v17 row_half_mirror row_mask:0xf bank_mask:0xf
    v_add_f32_dpp v18, v34, v18 row_half_mirror row_mask:0xf bank_mask:0xf
    v_add_f32_dpp v19, v35, v19 row_half_mirror row_mask:0xf bank_mask:0xf
    v_cndmask_b32 v32, v18, v16, s[50:51]
    v_cndmask_b32 v33, v19, v17, s[50:51]
    v_cndmask_b32 v16, v16, v18, s[50:51]
    v_cndmask_b32 v17, v17, v19, s[50:51]
    s_nop 0
    v_add_f32_dpp v16, v32, v16 quad_perm:[3,2,1,0] row_mask:0xf bank_mask:0xf
    v_add_f32_dpp v17, v33, v17 quad_perm:[3,2,1,0] row_mask:0xf bank_mask:0xf
    v_cndmask_b32 v32, v17, v16, s[52:53]
    v_cndmask_b32 v16, v16, v17, s[52:53]
    s_nop 1
    v_add_f32_dpp v16, v32, v16 quad_perm:[1,0,3,2] row_mask:0xf bank_mask:0xf
    v_mov_b32 v8, v16
    v_cvt_pk_bf16_f32 v8, v8, v8
    v_lshlrev_b32 v8, 16, v8
    v_mul_f32 v8, 0x3db504f3, v8
    v_cvt_pk_bf16_f32 v8, v8, v8
    v_lshlrev_b32 v8, 16, v8
    v_mov_b32 v10, v8
    s_nop 1
    v_max_f32_dpp v10, v10, v10 row_ror:8 row_mask:0xf bank_mask:0xf
    s_nop 1
    v_max_f32_dpp v10, v10, v10 row_ror:4 row_mask:0xf bank_mask:0xf
    s_nop 1
    v_max_f32_dpp v10, v10, v10 row_ror:2 row_mask:0xf bank_mask:0xf
    s_nop 1
    v_max_f32_dpp v10, v10, v10 row_ror:1 row_mask:0xf bank_mask:0xf
    s_nop 1
    v_max_f32_dpp v10, v10, v10 row_bcast:15 row_mask:0xa bank_mask:0xf
    s_nop 1
    v_max_f32_dpp v10, v10, v10 row_bcast:31 row_mask:0xc bank_mask:0xf
    s_nop 0
    v_readlane_b32 s54, v10, 63
    s_nop 1
    v_subrev_f32 v9, s54, v8
    v_mul_f32 v9, 0x3fb8aa3b, v9
    v_exp_f32 v9, v9
    s_nop 0
    v_mov_b32 v10, v9
    s_nop 1
    v_add_f32_dpp v10, v10, v10 row_ror:8 row_mask:0xf bank_mask:0xf
    s_nop 1
    v_add_f32_dpp v10, v10, v10 row_ror:4 row_mask:0xf bank_mask:0xf
    s_nop 1
    v_add_f32_dpp v10, v10, v10 row_ror:2 row_mask:0xf bank_mask:0xf
    s_nop 1
    v_add_f32_dpp v10, v10, v10 row_ror:1 row_mask:0xf bank_mask:0xf
    s_nop 1
    v_add_f32_dpp v10, v10, v10 row_bcast:15 row_mask:0xa bank_mask:0xf
    s_nop 1
    v_add_f32_dpp v10, v10, v10 row_bcast:31 row_mask:0xc bank_mask:0xf
    s_nop 0
    v_readlane_b32 s55, v10, 63
    v_mov_b32 v10, s54
    s_nop 0
    v_mov_b32 v11, s55
    s_lshl_b32 s57, s3, 3
    v_mov_b32 v12, s57
    s_mov_b64 exec, 1
    ds_write_b64 v12, v[10:11] offset:4352
    s_mov_b64 exec, -1
    s_waitcnt lgkmcnt(0)
    v_mov_b32 v12, 0
    v_mov_b32 v13, 1
    s_mov_b64 exec, 1
    ds_add_u32 v12, v13 offset:4444
    s_mov_b64 exec, -1
    s_cmp_eq_u32 s3, 0
    s_cbranch_scc0 L_stat_skip
    v_mov_b32 v12, 0
L_wait_ws_8:
    ds_read_b32 v13, v12 offset:4444
    s_waitcnt lgkmcnt(0)
    v_readfirstlane_b32 s57, v13
    s_cmp_lt_u32 s57, 8
    s_cbranch_scc1 L_wait_ws_8
    v_and_b32 v12, 7, v1
    v_lshlrev_b32 v13, 3, v12
    ds_read_b64 v[16:17], v13 offset:4352
    s_waitcnt lgkmcnt(0)
    v_mov_b32 v14, v16
    s_nop 1
    v_max_f32_dpp v14, v14, v14 quad_perm:[1,0,3,2] row_mask:0xf bank_mask:0xf
    s_nop 1
    v_max_f32_dpp v14, v14, v14 quad_perm:[2,3,0,1] row_mask:0xf bank_mask:0xf
    s_nop 1
    v_max_f32_dpp v14, v14, v14 row_half_mirror row_mask:0xf bank_mask:0xf
    v_sub_f32 v15, v16, v14
    v_mul_f32 v15, 0x3fb8aa3b, v15
    v_exp_f32 v15, v15
    s_nop 0
    v_mul_f32 v17, v17, v15
    s_nop 1
    v_add_f32_dpp v17, v17, v17 quad_perm:[1,0,3,2] row_mask:0xf bank_mask:0xf
    s_nop 1
    v_add_f32_dpp v17, v17, v17 quad_perm:[2,3,0,1] row_mask:0xf bank_mask:0xf
    s_nop 1
    v_add_f32_dpp v17, v17, v17 row_half_mirror row_mask:0xf bank_mask:0xf
    v_mov_b32 v16, v14
    v_mov_b32 v18, s98
    v_mov_b32 v19, s99
    v_mov_b32 v13, 0
    s_mov_b64 exec, 1
    s_add_u32 s76, s10, 4194304
    s_addc_u32 s77, s11, 0
    global_store_dwordx4 v13, v[16:19], s[76:77] offset:1024
    global_store_dwordx4 v13, v[16:19], s[10:11] offset:1024 sc1
    s_mov_b64 exec, -1
    v_mov_b32 v13, 0
    v_mov_b32 v14, 1
    s_mov_b64 exec, 1
    ds_add_u32 v13, v14 offset:4460
    s_mov_b64 exec, -1
    s_lshl_b32 s54, s6, 14
    s_lshl_b32 s55, s4, 11
    s_add_u32 s54, s54, s55
    s_add_u32 s74, s40, s54
    s_addc_u32 s75, s41, 0
    v_lshlrev_b32 v13, 16, v12
    s_add_u32 s76, s74, 4194304
    s_addc_u32 s77, s75, 0
    s_mov_b32 s56, 8
L_stat_loc:
    global_load_dwordx4 v[16:19], v13, s[76:77] offset:1024 nt
    s_waitcnt vmcnt(0)
    v_xor_b32 v20, s98, v18
    v_xor_b32 v21, s99, v19
    v_or_b32 v20, v20, v21
    v_cmp_ne_u32 vcc, 0, v20
    s_cbranch_vccz L_stat_got2
    s_sub_u32 s56, s56, 1
    s_cmp_lg_u32 s56, 0
    s_cbranch_scc1 L_stat_loc
    s_mov_b32 s56, 30000
L_stat_poll_9:
    global_load_dwordx4 v[16:19], v13, s[74:75] offset:1024 sc1
    s_waitcnt vmcnt(0)
    v_xor_b32 v20, s98, v18
    v_xor_b32 v21, s99, v19
    v_or_b32 v20, v20, v21
    v_cmp_ne_u32 vcc, 0, v20
    s_cbranch_vccz L_stat_poll_ok_10
    s_sub_u32 s56, s56, 1
    s_cmp_lg_u32 s56, 0
    s_cbranch_scc1 L_stat_poll_9
L_stat_poll_ok_10:
L_stat_got2:
    v_mov_b32 v14, v16
    s_nop 1
    v_max_f32_dpp v14, v14, v14 quad_perm:[1,0,3,2] row_mask:0xf bank_mask:0xf
    s_nop 1
    v_max_f32_dpp v14, v14, v14 quad_perm:[2,3,0,1] row_mask:0xf bank_mask:0xf
    s_nop 1
    v_max_f32_dpp v14, v14, v14 row_half_mirror row_mask:0xf bank_mask:0xf
    v_sub_f32 v15, v16, v14
    v_mul_f32 v15, 0x3fb8aa3b, v15
    v_exp_f32 v15, v15
    s_nop 0
    v_mul_f32 v17, v17, v15
    s_nop 1
    v_add_f32_dpp v17, v17, v17 quad_perm:[1,0,3,2] row_mask:0xf bank_mask:0xf
    s_nop 1
    v_add_f32_dpp v17, v17, v17 quad_perm:[2,3,0,1] row_mask:0xf bank_mask:0xf
    s_nop 1
    v_add_f32_dpp v17, v17, v17 row_half_mirror row_mask:0xf bank_mask:0xf
    v_mov_b32 v16, v14
    v_rcp_f32 v17, v17
    v_mov_b32 v13, 0
    s_mov_b64 exec, 1
    ds_write_b64 v13, v[16:17] offset:4416
    s_mov_b64 exec, -1
    s_waitcnt lgkmcnt(0)
    v_mov_b32 v12, 0
    v_mov_b32 v13, 1
    s_mov_b64 exec, 1
    ds_add_u32 v12, v13 offset:4448
    s_mov_b64 exec, -1
L_stat_skip:
    v_mov_b32 v12, 0
L_wait_gs_11:
    ds_read_b32 v13, v12 offset:4448
    s_waitcnt lgkmcnt(0)
    v_readfirstlane_b32 s57, v13
    s_cmp_lt_u32 s57, 1
    s_cbranch_scc1 L_wait_gs_11
    v_mov_b32 v13, 0
    ds_read_b64 v[10:11], v13 offset:4416
    s_waitcnt lgkmcnt(0)
    v_sub_f32 v9, v8, v10
    v_mul_f32 v9, 0x3fb8aa3b, v9
    v_exp_f32 v9, v9
    s_nop 0
    v_mul_f32 v9, v9, v11
    v_cvt_pk_bf16_f32 v9, v9, v9
    v_lshlrev_b32 v13, 1, v0
    ds_write_b16 v13, v9 offset:4480
    s_waitcnt lgkmcnt(0)
    v_mov_b32 v12, 0
    v_mov_b32 v13, 1
    s_mov_b64 exec, 1
    ds_add_u32 v12, v13 offset:4452
    s_mov_b64 exec, -1
    v_and_b32 v3, 15, v1
    v_lshlrev_b32 v4, 8, v2
    v_lshl_add_u32 v4, v3, 1, v4
    s_lshl_b32 s54, s9, 11
    s_add_u32 s54, s54, 13824
    v_add_u32 v6, s54, v4
    ds_read_u16 v104, v6 offset:0
    ds_read_u16 v105, v6 offset:32
    ds_read_u16 v106, v6 offset:64
    ds_read_u16 v107, v6 offset:96
    ds_read_u16 v108, v6 offset:128
    ds_read_u16 v109, v6 offset:160
    ds_read_u16 v110, v6 offset:192
    ds_read_u16 v111, v6 offset:224
    s_waitcnt lgkmcnt(0)
    v_lshl_or_b32 v64, v105, 16, v104
    v_lshl_or_b32 v65, v107, 16, v106
    v_lshl_or_b32 v66, v109, 16, v108
    v_lshl_or_b32 v67, v111, 16, v110
    ds_read_u16 v112, v6 offset:1024
    ds_read_u16 v113, v6 offset:1056
    ds_read_u16 v114, v6 offset:1088
    ds_read_u16 v115, v6 offset:1120
    ds_read_u16 v116, v6 offset:1152
    ds_read_u16 v117, v6 offset:1184
    ds_read_u16 v118, v6 offset:1216
    ds_read_u16 v119, v6 offset:1248
    s_waitcnt lgkmcnt(0)
    v_lshl_or_b32 v68, v113, 16, v112
    v_lshl_or_b32 v69, v115, 16, v114
    v_lshl_or_b32 v70, v117, 16, v116
    v_lshl_or_b32 v71, v119, 16, v118
    s_cmp_ge_u32 s2, 43
    s_cbranch_scc1 L_frags_done
    v_lshlrev_b32 v56, 16, v56
    v_lshlrev_b32 v57, 16, v57
    s_cmp_ge_u32 s2, 32
    s_cbranch_scc1 L_frags_done
    v_lshlrev_b32 v58, 16, v58
L_frags_done:
    v_and_b32 v48, 31, v1
    v_lshlrev_b32 v48, 4, v48
    s_lshl_b32 s54, s9, 7
    v_lshl_add_u32 v49, v2, 4, s54
    s_lshl_b32 s54, s9, 6
    v_lshl_add_u32 v50, v3, 2, s54
    v_lshlrev_b32 v51, 2, v3
    v_lshlrev_b32 v52, 1, v5
    s_barrier
    s_cmp_eq_u32 s3, 0
    s_cbranch_scc0 L_o_skip
    v_lshlrev_b32 v8, 3, v1
    ds_read_b64 v[16:17], v8 offset:5504
    ds_read_b64 v[18:19], v8 offset:6016
    ds_read_b64 v[20:21], v8 offset:6528
    ds_read_b64 v[22:23], v8 offset:7040
    ds_read_b64 v[24:25], v8 offset:7552
    ds_read_b64 v[26:27], v8 offset:8064
    ds_read_b64 v[28:29], v8 offset:8576
    ds_read_b64 v[30:31], v8 offset:9088
    s_waitcnt lgkmcnt(0)
    v_add_f32 v16, v16, v18
    v_add_f32 v20, v20, v22
    v_add_f32 v24, v24, v26
    v_add_f32 v28, v28, v30
    v_add_f32 v16, v16, v20
    v_add_f32 v24, v24, v28
    v_add_f32 v16, v16, v24
    v_add_f32 v17, v17, v19
    v_add_f32 v21, v21, v23
    v_add_f32 v25, v25, v27
    v_add_f32 v29, v29, v31
    v_add_f32 v17, v17, v21
    v_add_f32 v25, v25, v29
    v_add_f32 v17, v17, v25
    v_mov_b32 v18, s98
    v_mov_b32 v19, s99
    v_lshlrev_b32 v8, 4, v1
    s_add_u32 s74, s10, 4194304
    s_addc_u32 s75, s11, 0
    global_store_dwordx4 v8, v[16:19], s[74:75] offset:0
    global_store_dwordx4 v8, v[16:19], s[10:11] offset:0 sc1
L_o_skip:
    s_lshr_b32 s54, s9, 1
    s_lshl_b32 s54, s54, 14
    s_lshl_b32 s55, s4, 11
    s_add_u32 s54, s54, s55
    s_and_b32 s55, s9, 1
    s_lshl_b32 s55, s55, 9
    s_add_u32 s54, s54, s55
    s_add_u32 s55, s54, 0
    s_add_u32 s58, s40, s55
    s_addc_u32 s59, s41, 0
    s_add_u32 s55, s54, 65536
    s_add_u32 s60, s40, s55
    s_addc_u32 s61, s41, 0
    s_add_u32 s55, s54, 131072
    s_add_u32 s62, s40, s55
    s_addc_u32 s63, s41, 0
    s_add_u32 s55, s54, 196608
    s_add_u32 s64, s40, s55
    s_addc_u32 s65, s41, 0
    v_lshrrev_b32 v8, 5, v1
    v_lshlrev_b32 v8, 18, v8
    v_add_u32 v8, v8, v48
    s_cmp_ge_u32 s2, 43
    s_cbranch_scc1 L_nowait_tiles
    v_mov_b32 v9, 0
L_wait_tiles_12:
    ds_read_b32 v10, v9 offset:4456
    s_waitcnt lgkmcnt(0)
    v_readfirstlane_b32 s57, v10
    s_cmp_lt_u32 s57, 8
    s_cbranch_scc1 L_wait_tiles_12
L_nowait_tiles:
    s_add_u32 s66, s58, 4194304
    s_addc_u32 s67, s59, 0
    s_add_u32 s68, s60, 4194304
    s_addc_u32 s69, s61, 0
    s_add_u32 s70, s62, 4194304
    s_addc_u32 s71, s63, 0
    s_add_u32 s72, s64, 4194304
    s_addc_u32 s73, s65, 0
    s_mov_b32 s56, 8
L_pollB_loc:
    global_load_dwordx4 v[16:19], v8, s[66:67] nt
    global_load_dwordx4 v[20:23], v8, s[68:69] nt
    global_load_dwordx4 v[24:27], v8, s[70:71] nt
    global_load_dwordx4 v[28:31], v8, s[72:73] nt
    s_waitcnt vmcnt(0)
    v_xor_b32 v9, s98, v18
    v_xor_b32 v10, s99, v19
    v_or_b32 v9, v9, v10
    v_xor_b32 v10, s98, v22
    v_xor_b32 v11, s99, v23
    v_or3_b32 v9, v9, v10, v11
    v_xor_b32 v10, s98, v26
    v_xor_b32 v11, s99, v27
    v_or3_b32 v9, v9, v10, v11
    v_xor_b32 v10, s98, v30
    v_xor_b32 v11, s99, v31
    v_or3_b32 v9, v9, v10, v11
    v_cmp_ne_u32 vcc, 0, v9
    s_cbranch_vccz L_pollB_ok
    s_sub_u32 s56, s56, 1
    s_cmp_lg_u32 s56, 0
    s_cbranch_scc1 L_pollB_loc
    s_mov_b32 s56, 30000
L_pollB_both:
    global_load_dwordx4 v[16:19], v8, s[66:67] nt
    global_load_dwordx4 v[20:23], v8, s[68:69] nt
    global_load_dwordx4 v[24:27], v8, s[70:71] nt
    global_load_dwordx4 v[28:31], v8, s[72:73] nt
    global_load_dwordx4 v[104:107], v8, s[58:59] sc1
    global_load_dwordx4 v[108:111], v8, s[60:61] sc1
    global_load_dwordx4 v[112:115], v8, s[62:63] sc1
    global_load_dwordx4 v[116:119], v8, s[64:65] sc1
    s_waitcnt vmcnt(4)
    v_xor_b32 v9, s98, v18
    v_xor_b32 v10, s99, v19
    v_or_b32 v9, v9, v10
    v_xor_b32 v10, s98, v22
    v_xor_b32 v11, s99, v23
    v_or3_b32 v9, v9, v10, v11
    v_xor_b32 v10, s98, v26
    v_xor_b32 v11, s99, v27
    v_or3_b32 v9, v9, v10, v11
    v_xor_b32 v10, s98, v30
    v_xor_b32 v11, s99, v31
    v_or3_b32 v9, v9, v10, v11
    v_cmp_ne_u32 vcc, 0, v9
    s_cbranch_vccz L_pollB_ok
    s_waitcnt vmcnt(0)
    v_xor_b32 v9, s98, v106
    v_xor_b32 v10, s99, v107
    v_or_b32 v9, v9, v10
    v_xor_b32 v10, s98, v110
    v_xor_b32 v11, s99, v111
    v_or3_b32 v9, v9, v10, v11
    v_xor_b32 v10, s98, v114
    v_xor_b32 v11, s99, v115
    v_or3_b32 v9, v9, v10, v11
    v_xor_b32 v10, s98, v118
    v_xor_b32 v11, s99, v119
    v_or3_b32 v9, v9, v10, v11
    v_cmp_ne_u32 vcc, 0, v9
    s_cbranch_vccz L_pollB_glob
    s_sub_u32 s56, s56, 1
    s_cmp_lg_u32 s56, 0
    s_cbranch_scc1 L_pollB_both
L_pollB_glob:
    s_waitcnt vmcnt(0)
    v_mov_b32 v16, v104
    v_mov_b32 v17, v105
    v_mov_b32 v20, v108
    v_mov_b32 v21, v109
    v_mov_b32 v24, v112
    v_mov_b32 v25, v113
    v_mov_b32 v28, v116
    v_mov_b32 v29, v117
L_pollB_ok:
    v_add_f32 v16, v16, v20
    v_add_f32 v24, v24, v28
    v_add_f32 v17, v17, v21
    v_add_f32 v25, v25, v29
    v_add_f32 v16, v16, v24
    v_add_f32 v17, v17, v25
    s_nop 1
    v_permlane32_swap_b32 v16, v17
    v_add_f32 v16, v16, v17
    v_cvt_pk_bf16_f32 v16, v16, v16
    ds_write_b16 v52, v16 offset:12672
    s_waitcnt lgkmcnt(0)
    ds_read_b128 v[24:27], v49 offset:12672
    ds_read_b128 v[28:31], v49 offset:12736
    s_waitcnt lgkmcnt(0)
    v_mfma_f32_16x16x32_bf16 v[32:35], v[24:27], v[64:67], 0
    v_mfma_f32_16x16x32_bf16 v[32:35], v[28:31], v[68:71], v[32:35]
    s_mov_b64 exec, 0xffff
    s_nop 6
    ds_write_b32 v50, v32 offset:9600
    s_mov_b64 exec, -1
    s_waitcnt lgkmcnt(0)
    s_barrier
    s_cmp_eq_u32 s3, 0
    s_cbranch_scc0 L_B_done
    ds_read_b32 v36, v51 offset:9600
    ds_read_b32 v37, v51 offset:9664
    ds_read_b32 v38, v51 offset:9728
    ds_read_b32 v39, v51 offset:9792
    ds_read_b32 v40, v51 offset:9856
    ds_read_b32 v41, v51 offset:9920
    ds_read_b32 v42, v51 offset:9984
    ds_read_b32 v43, v51 offset:10048
    s_waitcnt lgkmcnt(0)
    v_add_f32 v36, v36, v37
    v_add_f32 v38, v38, v39
    v_add_f32 v40, v40, v41
    v_add_f32 v42, v42, v43
    v_add_f32 v36, v36, v38
    v_add_f32 v40, v40, v42
    v_add_f32 v36, v36, v40
    s_nop 1
    v_mov_b32_dpp v37, v36 quad_perm:[1,0,3,2] row_mask:0xf bank_mask:0xf
    v_mov_b32 v38, s98
    v_mov_b32 v39, s99
    v_lshlrev_b32 v40, 3, v3
    s_mov_b64 exec, 0x5555
    global_store_dwordx4 v40, v[36:39], s[10:11] offset:1152 sc1
    s_mov_b64 exec, -1
L_B_done:
    s_cmp_ge_u32 s2, 43
    s_cbranch_scc1 L_end
    s_waitcnt vmcnt(0)
    v_lshlrev_b32 v4, 9, v2
    v_lshl_add_u32 v4, v3, 1, v4
    s_lshl_b32 s54, s9, 12
    s_add_u32 s54, s54, 30208
    v_add_u32 v6, s54, v4
    ds_read_u16 v104, v6 offset:0
    ds_read_u16 v105, v6 offset:64
    ds_read_u16 v106, v6 offset:128
    ds_read_u16 v107, v6 offset:192
    ds_read_u16 v108, v6 offset:256
    ds_read_u16 v109, v6 offset:320
    ds_read_u16 v110, v6 offset:384
    ds_read_u16 v111, v6 offset:448
    s_waitcnt lgkmcnt(0)
    v_lshl_or_b32 v72, v105, 16, v104
    v_lshl_or_b32 v73, v107, 16, v106
    v_lshl_or_b32 v74, v109, 16, v108
    v_lshl_or_b32 v75, v111, 16, v110
    ds_read_u16 v112, v6 offset:32
    ds_read_u16 v113, v6 offset:96
    ds_read_u16 v114, v6 offset:160
    ds_read_u16 v115, v6 offset:224
    ds_read_u16 v116, v6 offset:288
    ds_read_u16 v117, v6 offset:352
    ds_read_u16 v118, v6 offset:416
    ds_read_u16 v119, v6 offset:480
    s_waitcnt lgkmcnt(0)
    v_lshl_or_b32 v76, v113, 16, v112
    v_lshl_or_b32 v77, v115, 16, v114
    v_lshl_or_b32 v78, v117, 16, v116
    v_lshl_or_b32 v79, v119, 16, v118
    ds_read_u16 v120, v6 offset:2048
    ds_read_u16 v121, v6 offset:2112
    ds_read_u16 v122, v6 offset:2176
    ds_read_u16 v123, v6 offset:2240
    ds_read_u16 v124, v6 offset:2304
    ds_read_u16 v125, v6 offset:2368
    ds_read_u16 v126, v6 offset:2432
    ds_read_u16 v127, v6 offset:2496
    s_waitcnt lgkmcnt(0)
    v_lshl_or_b32 v80, v121, 16, v120
    v_lshl_or_b32 v81, v123, 16, v122
    v_lshl_or_b32 v82, v125, 16, v124
    v_lshl_or_b32 v83, v127, 16, v126
    ds_read_u16 v104, v6 offset:2080
    ds_read_u16 v105, v6 offset:2144
    ds_read_u16 v106, v6 offset:2208
    ds_read_u16 v107, v6 offset:2272
    ds_read_u16 v108, v6 offset:2336
    ds_read_u16 v109, v6 offset:2400
    ds_read_u16 v110, v6 offset:2464
    ds_read_u16 v111, v6 offset:2528
    s_waitcnt lgkmcnt(0)
    v_lshl_or_b32 v84, v105, 16, v104
    v_lshl_or_b32 v85, v107, 16, v106
    v_lshl_or_b32 v86, v109, 16, v108
    v_lshl_or_b32 v87, v111, 16, v110
    v_lshlrev_b32 v4, 13, v2
    v_lshl_add_u32 v4, v3, 1, v4
    s_lshl_b32 s54, s9, 7
    s_add_u32 s54, s54, 62976
    v_add_u32 v6, s54, v4
    ds_read_u16 v104, v6 offset:0
    ds_read_u16 v105, v6 offset:1024
    ds_read_u16 v106, v6 offset:2048
    ds_read_u16 v107, v6 offset:3072
    ds_read_u16 v108, v6 offset:4096
    ds_read_u16 v109, v6 offset:5120
    ds_read_u16 v110, v6 offset:6144
    ds_read_u16 v111, v6 offset:7168
    s_waitcnt lgkmcnt(0)
    v_lshl_or_b32 v88, v105, 16, v104
    v_lshl_or_b32 v89, v107, 16, v106
    v_lshl_or_b32 v90, v109, 16, v108
    v_lshl_or_b32 v91, v111, 16, v110
    ds_read_u16 v112, v6 offset:32
    ds_read_u16 v113, v6 offset:1056
    ds_read_u16 v114, v6 offset:2080
    ds_read_u16 v115, v6 offset:3104
    ds_read_u16 v116, v6 offset:4128
    ds_read_u16 v117, v6 offset:5152
    ds_read_u16 v118, v6 offset:6176
    ds_read_u16 v119, v6 offset:7200
    s_waitcnt lgkmcnt(0)
    v_lshl_or_b32 v92, v113, 16, v112
    v_lshl_or_b32 v93, v115, 16, v114
    v_lshl_or_b32 v94, v117, 16, v116
    v_lshl_or_b32 v95, v119, 16, v118
    ds_read_u16 v120, v6 offset:64
    ds_read_u16 v121, v6 offset:1088
    ds_read_u16 v122, v6 offset:2112
    ds_read_u16 v123, v6 offset:3136
    ds_read_u16 v124, v6 offset:4160
    ds_read_u16 v125, v6 offset:5184
    ds_read_u16 v126, v6 offset:6208
    ds_read_u16 v127, v6 offset:7232
    s_waitcnt lgkmcnt(0)
    v_lshl_or_b32 v96, v121, 16, v120
    v_lshl_or_b32 v97, v123, 16, v122
    v_lshl_or_b32 v98, v125, 16, v124
    v_lshl_or_b32 v99, v127, 16, v126
    ds_read_u16 v104, v6 offset:96
    ds_read_u16 v105, v6 offset:1120
    ds_read_u16 v106, v6 offset:2144
    ds_read_u16 v107, v6 offset:3168
    ds_read_u16 v108, v6 offset:4192
    ds_read_u16 v109, v6 offset:5216
    ds_read_u16 v110, v6 offset:6240
    ds_read_u16 v111, v6 offset:7264
    s_waitcnt lgkmcnt(0)
    v_lshl_or_b32 v100, v105, 16, v104
    v_lshl_or_b32 v101, v107, 16, v106
    v_lshl_or_b32 v102, v109, 16, v108
    v_lshl_or_b32 v103, v111, 16, v110
    v_and_b32 v8, 31, v1
    v_lshrrev_b32 v9, 3, v8
    v_lshlrev_b32 v9, 14, v9
    v_and_b32 v8, 7, v8
    v_lshl_add_u32 v9, v8, 4, v9
    v_lshrrev_b32 v8, 5, v1
    v_lshl_add_u32 v8, v8, 13, v9
    s_lshl_b32 s54, s9, 16
    s_add_u32 s54, s54, 1152
    s_add_u32 s55, s54, 0
    s_add_u32 s58, s40, s55
    s_addc_u32 s59, s41, 0
    s_add_u32 s55, s54, 2048
    s_add_u32 s60, s40, s55
    s_addc_u32 s61, s41, 0
    s_add_u32 s55, s54, 4096
    s_add_u32 s62, s40, s55
    s_addc_u32 s63, s41, 0
    s_add_u32 s55, s54, 6144
    s_add_u32 s64, s40, s55
    s_addc_u32 s65, s41, 0
    s_mov_b32 s56, 30000
L_pollC_13:
    global_load_dwordx4 v[16:19], v8, s[58:59] sc1
    global_load_dwordx4 v[20:23], v8, s[60:61] sc1
    global_load_dwordx4 v[24:27], v8, s[62:63] sc1
    global_load_dwordx4 v[28:31], v8, s[64:65] sc1
    s_waitcnt vmcnt(0)
    v_xor_b32 v32, s98, v18
    v_xor_b32 v33, s99, v19
    v_or_b32 v32, v32, v33
    v_xor_b32 v33, s98, v22
    v_xor_b32 v34, s99, v23
    v_or3_b32 v32, v32, v33, v34
    v_xor_b32 v33, s98, v26
    v_xor_b32 v34, s99, v27
    v_or3_b32 v32, v32, v33, v34
    v_xor_b32 v33, s98, v30
    v_xor_b32 v34, s99, v31
    v_or3_b32 v32, v32, v33, v34
    v_cmp_ne_u32 vcc, 0, v32
    s_cbranch_vccz L_pollC_ok_14
    s_sub_u32 s56, s56, 1
    s_cmp_lg_u32 s56, 0
    s_cbranch_scc1 L_pollC_13
L_pollC_ok_14:
    v_add_f32 v16, v16, v20
    v_add_f32 v24, v24, v28
    v_add_f32 v17, v17, v21
    v_add_f32 v25, v25, v29
    v_add_f32 v16, v16, v24
    v_add_f32 v17, v17, v25
    s_nop 1
    v_permlane32_swap_b32 v16, v17
    v_add_f32 v16, v16, v17
    v_cvt_pk_bf16_f32 v16, v16, v16
    v_lshlrev_b32 v16, 16, v16
    v_add_f32 v59, v56, v16
    v_cvt_pk_bf16_f32 v59, v59, v59
    v_lshlrev_b32 v59, 16, v59
    v_lshlrev_b32 v8, 2, v5
    ds_write_b32 v8, v59 offset:10624
    s_waitcnt lgkmcnt(0)
    s_barrier
    v_lshlrev_b32 v8, 5, v1
    ds_read_b128 v[16:19], v8 offset:10624
    ds_read_b128 v[20:23], v8 offset:10640
    s_waitcnt lgkmcnt(0)
    v_add_f32 v24, v16, v17
    v_add_f32 v26, v18, v19
    v_add_f32 v25, v20, v21
    v_add_f32 v27, v22, v23
    v_add_f32 v24, v24, v26
    v_add_f32 v25, v25, v27
    v_add_f32 v24, v24, v25
    s_nop 1
    v_add_f32_dpp v24, v24, v24 row_ror:8 row_mask:0xf bank_mask:0xf
    s_nop 1
    v_add_f32_dpp v24, v24, v24 row_ror:4 row_mask:0xf bank_mask:0xf
    s_nop 1
    v_add_f32_dpp v24, v24, v24 row_ror:2 row_mask:0xf bank_mask:0xf
    s_nop 1
    v_add_f32_dpp v24, v24, v24 row_ror:1 row_mask:0xf bank_mask:0xf
    s_nop 1
    v_add_f32_dpp v24, v24, v24 row_bcast:15 row_mask:0xa bank_mask:0xf
    s_nop 1
    v_add_f32_dpp v24, v24, v24 row_bcast:31 row_mask:0xc bank_mask:0xf
    s_nop 0
    v_readlane_b32 s54, v24, 63
    s_nop 1
    v_mov_b32 v25, s54
    v_mul_f32 v25, 0x3b000000, v25
    v_sub_f32 v16, v16, v25
    v_sub_f32 v17, v17, v25
    v_sub_f32 v18, v18, v25
    v_sub_f32 v19, v19, v25
    v_sub_f32 v20, v20, v25
    v_sub_f32 v21, v21, v25
    v_sub_f32 v22, v22, v25
    v_sub_f32 v23, v23, v25
    v_mul_f32 v24, v16, v16
    v_fma_f32 v24, v17, v17, v24
    v_fma_f32 v24, v18, v18, v24
    v_fma_f32 v24, v19, v19, v24
    v_fma_f32 v24, v20, v20, v24
    v_fma_f32 v24, v21, v21, v24
    v_fma_f32 v24, v22, v22, v24
    v_fma_f32 v24, v23, v23, v24
    s_nop 1
    v_add_f32_dpp v24, v24, v24 row_ror:8 row_mask:0xf bank_mask:0xf
    s_nop 1
    v_add_f32_dpp v24, v24, v24 row_ror:4 row_mask:0xf bank_mask:0xf
    s_nop 1
    v_add_f32_dpp v24, v24, v24 row_ror:2 row_mask:0xf bank_mask:0xf
    s_nop 1
    v_add_f32_dpp v24, v24, v24 row_ror:1 row_mask:0xf bank_mask:0xf
    s_nop 1
    v_add_f32_dpp v24, v24, v24 row_bcast:15 row_mask:0xa bank_mask:0xf
    s_nop 1
    v_add_f32_dpp v24, v24, v24 row_bcast:31 row_mask:0xc bank_mask:0xf
    s_nop 0
    v_readlane_b32 s54, v24, 63
    s_nop 1
    v_mov_b32 v26, s54
    v_mul_f32 v26, 0x3b000000, v26
    v_cvt_pk_bf16_f32 v26, v26, v26
    v_lshlrev_b32 v26, 16, v26
    v_add_f32 v26, 0x3727c5ac, v26
    v_cvt_pk_bf16_f32 v26, v26, v26
    v_lshlrev_b32 v26, 16, v26
    v_sqrt_f32 v27, v26
    s_nop 0
    v_cvt_pk_bf16_f32 v27, v27, v27
    v_lshlrev_b32 v27, 16, v27
    v_rcp_f32 v28, v27
    v_cvt_pk_bf16_f32 v25, v25, v25
    v_lshlrev_b32 v25, 16, v25
    v_mov_b32 v29, v59
    v_sub_f32 v29, v29, v25
    v_cvt_pk_bf16_f32 v29, v29, v29
    v_lshlrev_b32 v29, 16, v29
    v_mul_f32 v30, v29, v28
    v_fma_f32 v31, -v30, v27, v29
    v_fma_f32 v29, v31, v28, v30
    v_cvt_pk_bf16_f32 v29, v29, v29
    ds_write_b16 v52, v29 offset:12672
    s_waitcnt lgkmcnt(0)
    ds_read_b128 v[24:27], v49 offset:12672
    ds_read_b128 v[28:31], v49 offset:12736
    s_waitcnt lgkmcnt(0)
    v_mfma_f32_16x16x32_bf16 v[32:35], v[24:27], v[72:75], 0
    v_mfma_f32_16x16x32_bf16 v[36:39], v[24:27], v[76:79], 0
    v_mfma_f32_16x16x32_bf16 v[32:35], v[28:31], v[80:83], v[32:35]
    v_mfma_f32_16x16x32_bf16 v[36:39], v[28:31], v[84:87], v[36:39]
    s_lshl_b32 s54, s9, 7
    v_lshl_add_u32 v8, v3, 2, s54
    s_mov_b64 exec, 0xffff
    s_nop 3
    ds_write_b32 v8, v32 offset:9600
    ds_write_b32 v8, v36 offset:9664
    s_mov_b64 exec, -1
    s_waitcnt lgkmcnt(0)
    s_barrier
    s_cmp_eq_u32 s3, 0
    s_cbranch_scc0 L_C_done
    v_and_b32 v8, 31, v1
    v_lshlrev_b32 v8, 2, v8
    ds_read_b32 v36, v8 offset:9600
    ds_read_b32 v37, v8 offset:9728
    ds_read_b32 v38, v8 offset:9856
    ds_read_b32 v39, v8 offset:9984
    ds_read_b32 v40, v8 offset:10112
    ds_read_b32 v41, v8 offset:10240
    ds_read_b32 v42, v8 offset:10368
    ds_read_b32 v43, v8 offset:10496
    s_waitcnt lgkmcnt(0)
    v_add_f32 v36, v36, v37
    v_add_f32 v38, v38, v39
    v_add_f32 v40, v40, v41
    v_add_f32 v42, v42, v43
    v_add_f32 v36, v36, v38
    v_add_f32 v40, v40, v42
    v_add_f32 v36, v36, v40
    v_cvt_pk_bf16_f32 v36, v36, v36
    v_lshlrev_b32 v36, 16, v36
    v_add_f32 v36, v36, v57
    v_cvt_pk_bf16_f32 v36, v36, v36
    v_lshlrev_b32 v36, 16, v36
    v_max_f32 v36, 0, v36
    v_mul_f32 v36, v36, v36
    v_cvt_pk_bf16_f32 v36, v36, v36
    v_lshrrev_b32 v8, 1, v8
    s_mov_b32 exec_hi, 0
    ds_write_b16 v8, v36 offset:13696
    s_mov_b32 exec_hi, -1
    s_waitcnt lgkmcnt(0)
L_C_done:
    s_barrier
    v_lshlrev_b32 v8, 4, v2
    ds_read_b128 v[24:27], v8 offset:13696
    v_cmp_eq_u32 s[46:47], 1, v2
    v_cmp_eq_u32 s[48:49], 2, v2
    v_cmp_eq_u32 s[50:51], 3, v2
    s_waitcnt lgkmcnt(0)
    v_mfma_f32_16x16x32_bf16 v[28:31], v[24:27], v[88:91], 0
    v_mfma_f32_16x16x32_bf16 v[32:35], v[24:27], v[92:95], 0
    v_mfma_f32_16x16x32_bf16 v[36:39], v[24:27], v[96:99], 0
    v_mfma_f32_16x16x32_bf16 v[40:43], v[24:27], v[100:103], 0
    s_nop 4
    v_mov_b32 v44, v28
    v_cndmask_b32 v44, v44, v32, s[46:47]
    v_cndmask_b32 v44, v44, v36, s[48:49]
    v_cndmask_b32 v44, v44, v40, s[50:51]
    s_nop 1
    v_mov_b32_dpp v45, v44 quad_perm:[1,0,3,2] row_mask:0xf bank_mask:0xf
    v_mov_b32 v46, s98
    v_mov_b32 v47, s99
    s_lshl_b32 s54, s2, 12
    s_lshl_b32 s55, s9, 9
    s_add_u32 s54, s54, s55
    s_add_u32 s54, s54, 524288
    s_add_u32 s74, s40, s54
    s_addc_u32 s75, s41, 0
    v_lshlrev_b32 v8, 3, v1
    s_mov_b32 exec_lo, 0x55555555
    s_mov_b32 exec_hi, 0x55555555
    global_store_dwordx4 v8, v[44:47], s[74:75] sc1
    s_mov_b64 exec, -1
    s_cmp_ge_u32 s2, 32
    s_cbranch_scc1 L_end
    s_cmp_ge_u32 s9, 6
    s_cbranch_scc1 L_D2_skip
    v_lshrrev_b32 v8, 3, v0
    v_lshlrev_b32 v8, 12, v8
    v_and_b32 v9, 7, v0
    v_lshl_add_u32 v8, v9, 4, v8
    s_lshl_b32 s54, s2, 7
    s_add_u32 s54, s54, 524288
    s_add_u32 s74, s40, s54
    s_addc_u32 s75, s41, 0
    v_mov_b32 v16, 0
    v_mov_b32 v17, 0
    v_cmp_gt_u32 vcc, 344, v0
    s_and_saveexec_b64 s[76:77], vcc
    s_mov_b32 s56, 30000
L_pollD_15:
    global_load_dwordx4 v[16:19], v8, s[74:75] sc1
    s_waitcnt vmcnt(0)
    v_xor_b32 v20, s98, v18
    v_xor_b32 v21, s99, v19
    v_or_b32 v20, v20, v21
    v_cmp_ne_u32 vcc, 0, v20
    s_cbranch_vccz L_pollD_ok_16
    s_sub_u32 s56, s56, 1
    s_cmp_lg_u32 s56, 0
    s_cbranch_scc1 L_pollD_15
L_pollD_ok_16:
    s_mov_b64 exec, s[76:77]
    v_add_f32_dpp v16, v16, v16 row_ror:8 row_mask:0xf bank_mask:0xf
    v_add_f32_dpp v17, v17, v17 row_ror:8 row_mask:0xf bank_mask:0xf
    s_nop 1
    v_permlane32_swap_b32 v16, v17
    v_add_f32 v16, v16, v17
    v_mov_b32 v17, v16
    s_nop 1
    v_permlane16_swap_b32 v16, v17
    v_add_f32 v16, v16, v17
    v_lshrrev_b32 v8, 5, v1
    v_lshl_or_b32 v8, v9, 1, v8
    s_lshl_b32 s54, s9, 6
    v_lshl_add_u32 v8, v8, 2, s54
    s_mov_b32 exec_lo, 0xff
    s_mov_b32 exec_hi, 0xff
    ds_write_b32 v8, v16 offset:9600
    s_mov_b64 exec, -1
    s_waitcnt lgkmcnt(0)
L_D2_skip:
    s_barrier
    s_cmp_eq_u32 s3, 0
    s_cbranch_scc0 L_end
    ds_read_b32 v36, v51 offset:9600
    ds_read_b32 v37, v51 offset:9664
    ds_read_b32 v38, v51 offset:9728
    ds_read_b32 v39, v51 offset:9792
    ds_read_b32 v40, v51 offset:9856
    ds_read_b32 v41, v51 offset:9920
    s_lshl_b32 s54, s2, 6
    v_add_u32 v8, s54, v51
    ds_read_b32 v9, v8 offset:10624
    s_waitcnt lgkmcnt(0)
    v_add_f32 v36, v36, v37
    v_add_f32 v38, v38, v39
    v_add_f32 v40, v40, v41
    v_add_f32 v36, v36, v38
    v_add_f32 v36, v36, v40
    v_cvt_pk_bf16_f32 v36, v36, v36
    v_lshlrev_b32 v36, 16, v36
    v_add_f32 v36, v36, v58
    v_cvt_pk_bf16_f32 v36, v36, v36
    v_lshlrev_b32 v36, 16, v36
    v_add_f32 v36, v9, v36
    v_cvt_pk_bf16_f32 v36, v36, v36
    v_lshrrev_b32 v8, 1, v8
    s_mov_b64 exec, 0xffff
    global_store_short v8, v36, s[36:37]
    s_cmp_eq_u32 s2, 0
    s_cbranch_scc0 L_end
    s_mov_b64 exec, 1
    v_mov_b32 v10, s98
    v_mov_b32 v11, s99
    v_mov_b32 v12, 1048576
    global_store_dwordx2 v12, v[10:11], s[40:41]
    s_branch L_end
L_vpath:
    s_cmp_eq_u32 s3, 8
    s_cbranch_scc0 L_noz
    v_mov_b32 v8, 0
    v_mov_b32 v9, 0
    v_mov_b32 v10, 0
    v_mov_b32 v11, 0
    ds_write_b128 v8, v[8:11] offset:4432
    ds_write_b128 v8, v[8:11] offset:4448
    ds_write_b128 v8, v[8:11] offset:4464
L_noz:
    v_lshlrev_b32 v5, 4, v1
    global_load_dwordx4 v[24:27], v5, s[16:17]
    s_lshl_b32 s54, s9, 7
    v_lshl_add_u32 v5, v2, 5, s54
    global_load_dwordx4 v[28:31], v5, s[16:17]
    global_load_dwordx4 v[32:35], v5, s[16:17] offset:16
    v_lshl_add_u32 v6, v2, 17, v3
    s_lshl_b32 s54, s8, 8
    s_lshl_b32 s55, s9, 19
    s_add_u32 s54, s54, s55
    s_add_u32 s44, s22, s54
    s_addc_u32 s45, s23, 0
    global_load_dwordx4 v[64:67], v6, s[44:45] nt
    s_add_u32 s12, s44, 8192
    s_addc_u32 s13, s45, 0
    global_load_dwordx4 v[68:71], v6, s[12:13] nt
    s_add_u32 s12, s44, 16384
    s_addc_u32 s13, s45, 0
    global_load_dwordx4 v[72:75], v6, s[12:13] nt
    s_add_u32 s12, s44, 24576
    s_addc_u32 s13, s45, 0
    global_load_dwordx4 v[76:79], v6, s[12:13] nt
    s_add_u32 s12, s44, 32768
    s_addc_u32 s13, s45, 0
    global_load_dwordx4 v[80:83], v6, s[12:13] nt
    s_add_u32 s12, s44, 40960
    s_addc_u32 s13, s45, 0
    global_load_dwordx4 v[84:87], v6, s[12:13] nt
    s_add_u32 s12, s44, 49152
    s_addc_u32 s13, s45, 0
    global_load_dwordx4 v[88:91], v6, s[12:13] nt
    s_add_u32 s12, s44, 57344
    s_addc_u32 s13, s45, 0
    global_load_dwordx4 v[92:95], v6, s[12:13] nt
    s_add_u32 s12, s44, 65536
    s_addc_u32 s13, s45, 0
    global_load_dwordx4 v[96:99], v6, s[12:13] nt
    s_add_u32 s12, s44, 73728
    s_addc_u32 s13, s45, 0
    global_load_dwordx4 v[100:103], v6, s[12:13] nt
    s_add_u32 s12, s44, 81920
    s_addc_u32 s13, s45, 0
    global_load_dwordx4 v[104:107], v6, s[12:13] nt
    s_add_u32 s12, s44, 90112
    s_addc_u32 s13, s45, 0
    global_load_dwordx4 v[108:111], v6, s[12:13] nt
    s_add_u32 s12, s44, 98304
    s_addc_u32 s13, s45, 0
    global_load_dwordx4 v[112:115], v6, s[12:13] nt
    s_add_u32 s12, s44, 106496
    s_addc_u32 s13, s45, 0
    global_load_dwordx4 v[116:119], v6, s[12:13] nt
    s_add_u32 s12, s44, 114688
    s_addc_u32 s13, s45, 0
    global_load_dwordx4 v[120:123], v6, s[12:13] nt
    s_add_u32 s12, s44, 122880
    s_addc_u32 s13, s45, 0
    global_load_dwordx4 v[124:127], v6, s[12:13] nt
    s_waitcnt lgkmcnt(0)
    s_barrier
    s_waitcnt vmcnt(18)
    v_lshlrev_b32 v8, 16, v24
    v_and_b32 v9, 0xffff0000, v24
    v_lshlrev_b32 v10, 16, v25
    v_and_b32 v11, 0xffff0000, v25
    v_lshlrev_b32 v12, 16, v26
    v_and_b32 v13, 0xffff0000, v26
    v_lshlrev_b32 v14, 16, v27
    v_and_b32 v15, 0xffff0000, v27
    v_add_f32 v16, v8, v9
    v_add_f32 v18, v10, v11
    v_add_f32 v17, v12, v13
    v_add_f32 v19, v14, v15
    v_add_f32 v16, v16, v18
    v_add_f32 v17, v17, v19
    v_add_f32 v16, v16, v17
    s_nop 1
    v_add_f32_dpp v16, v16, v16 row_ror:8 row_mask:0xf bank_mask:0xf
    s_nop 1
    v_add_f32_dpp v16, v16, v16 row_ror:4 row_mask:0xf bank_mask:0xf
    s_nop 1
    v_add_f32_dpp v16, v16, v16 row_ror:2 row_mask:0xf bank_mask:0xf
    s_nop 1
    v_add_f32_dpp v16, v16, v16 row_ror:1 row_mask:0xf bank_mask:0xf
    s_nop 1
    v_add_f32_dpp v16, v16, v16 row_bcast:15 row_mask:0xa bank_mask:0xf
    s_nop 1
    v_add_f32_dpp v16, v16, v16 row_bcast:31 row_mask:0xc bank_mask:0xf
    s_nop 0
    v_readlane_b32 s54, v16, 63
    s_nop 1
    v_mov_b32 v17, s54
    v_mul_f32 v17, 0x3b000000, v17
    v_sub_f32 v8, v8, v17
    v_sub_f32 v9, v9, v17
    v_sub_f32 v10, v10, v17
    v_sub_f32 v11, v11, v17
    v_sub_f32 v12, v12, v17
    v_sub_f32 v13, v13, v17
    v_sub_f32 v14, v14, v17
    v_sub_f32 v15, v15, v17
    v_mul_f32 v16, v8, v8
    v_fma_f32 v16, v9, v9, v16
    v_fma_f32 v16, v10, v10, v16
    v_fma_f32 v16, v11, v11, v16
    v_fma_f32 v16, v12, v12, v16
    v_fma_f32 v16, v13, v13, v16
    v_fma_f32 v16, v14, v14, v16
    v_fma_f32 v16, v15, v15, v16
    s_nop 1
    v_add_f32_dpp v16, v16, v16 row_ror:8 row_mask:0xf bank_mask:0xf
    s_nop 1
    v_add_f32_dpp v16, v16, v16 row_ror:4 row_mask:0xf bank_mask:0xf
    s_nop 1
    v_add_f32_dpp v16, v16, v16 row_ror:2 row_mask:0xf bank_mask:0xf
    s_nop 1
    v_add_f32_dpp v16, v16, v16 row_ror:1 row_mask:0xf bank_mask:0xf
    s_nop 1
    v_add_f32_dpp v16, v16, v16 row_bcast:15 row_mask:0xa bank_mask:0xf
    s_nop 1
    v_add_f32_dpp v16, v16, v16 row_bcast:31 row_mask:0xc bank_mask:0xf
    s_nop 0
    v_readlane_b32 s54, v16, 63
    s_nop 1
    v_mov_b32 v18, s54
    v_mul_f32 v18, 0x3b000000, v18
    v_cvt_pk_bf16_f32 v18, v18, v18
    v_lshlrev_b32 v18, 16, v18
    v_add_f32 v18, 0x3727c5ac, v18
    v_cvt_pk_bf16_f32 v18, v18, v18
    v_lshlrev_b32 v18, 16, v18
    v_sqrt_f32 v19, v18
    s_nop 0
    v_cvt_pk_bf16_f32 v19, v19, v19
    v_lshlrev_b32 v19, 16, v19
    v_rcp_f32 v20, v19
    v_cvt_pk_bf16_f32 v17, v17, v17
    v_lshlrev_b32 v17, 16, v17
    s_waitcnt vmcnt(16)
    v_lshlrev_b32 v36, 16, v28
    v_and_b32 v37, 0xffff0000, v28
    v_lshlrev_b32 v38, 16, v29
    v_and_b32 v39, 0xffff0000, v29
    v_lshlrev_b32 v40, 16, v30
    v_and_b32 v41, 0xffff0000, v30
    v_lshlrev_b32 v42, 16, v31
    v_and_b32 v43, 0xffff0000, v31
    v_lshlrev_b32 v44, 16, v32
    v_and_b32 v45, 0xffff0000, v32
    v_lshlrev_b32 v46, 16, v33
    v_and_b32 v47, 0xffff0000, v33
    v_lshlrev_b32 v48, 16, v34
    v_and_b32 v49, 0xffff0000, v34
    v_lshlrev_b32 v50, 16, v35
    v_and_b32 v51, 0xffff0000, v35
    v_sub_f32 v36, v36, v17
    v_cvt_pk_bf16_f32 v36, v36, v36
    v_lshlrev_b32 v36, 16, v36
    v_mul_f32 v21, v36, v20
    v_fma_f32 v22, -v21, v19, v36
    v_fma_f32 v36, v22, v20, v21
    v_sub_f32 v37, v37, v17
    v_cvt_pk_bf16_f32 v37, v37, v37
    v_lshlrev_b32 v37, 16, v37
    v_mul_f32 v21, v37, v20
    v_fma_f32 v22, -v21, v19, v37
    v_fma_f32 v37, v22, v20, v21
    v_sub_f32 v38, v38, v17
    v_cvt_pk_bf16_f32 v38, v38, v38
    v_lshlrev_b32 v38, 16, v38
    v_mul_f32 v21, v38, v20
    v_fma_f32 v22, -v21, v19, v38
    v_fma_f32 v38, v22, v20, v21
    v_sub_f32 v39, v39, v17
    v_cvt_pk_bf16_f32 v39, v39, v39
    v_lshlrev_b32 v39, 16, v39
    v_mul_f32 v21, v39, v20
    v_fma_f32 v22, -v21, v19, v39
    v_fma_f32 v39, v22, v20, v21
    v_sub_f32 v40, v40, v17
    v_cvt_pk_bf16_f32 v40, v40, v40
    v_lshlrev_b32 v40, 16, v40
    v_mul_f32 v21, v40, v20
    v_fma_f32 v22, -v21, v19, v40
    v_fma_f32 v40, v22, v20, v21
    v_sub_f32 v41, v41, v17
    v_cvt_pk_bf16_f32 v41, v41, v41
    v_lshlrev_b32 v41, 16, v41
    v_mul_f32 v21, v41, v20
    v_fma_f32 v22, -v21, v19, v41
    v_fma_f32 v41, v22, v20, v21
    v_sub_f32 v42, v42, v17
    v_cvt_pk_bf16_f32 v42, v42, v42
    v_lshlrev_b32 v42, 16, v42
    v_mul_f32 v21, v42, v20
    v_fma_f32 v22, -v21, v19, v42
    v_fma_f32 v42, v22, v20, v21
    v_sub_f32 v43, v43, v17
    v_cvt_pk_bf16_f32 v43, v43, v43
    v_lshlrev_b32 v43, 16, v43
    v_mul_f32 v21, v43, v20
    v_fma_f32 v22, -v21, v19, v43
    v_fma_f32 v43, v22, v20, v21
    v_sub_f32 v44, v44, v17
    v_cvt_pk_bf16_f32 v44, v44, v44
    v_lshlrev_b32 v44, 16, v44
    v_mul_f32 v21, v44, v20
    v_fma_f32 v22, -v21, v19, v44
    v_fma_f32 v44, v22, v20, v21
    v_sub_f32 v45, v45, v17
    v_cvt_pk_bf16_f32 v45, v45, v45
    v_lshlrev_b32 v45, 16, v45
    v_mul_f32 v21, v45, v20
    v_fma_f32 v22, -v21, v19, v45
    v_fma_f32 v45, v22, v20, v21
    v_sub_f32 v46, v46, v17
    v_cvt_pk_bf16_f32 v46, v46, v46
    v_lshlrev_b32 v46, 16, v46
    v_mul_f32 v21, v46, v20
    v_fma_f32 v22, -v21, v19, v46
    v_fma_f32 v46, v22, v20, v21
    v_sub_f32 v47, v47, v17
    v_cvt_pk_bf16_f32 v47, v47, v47
    v_lshlrev_b32 v47, 16, v47
    v_mul_f32 v21, v47, v20
    v_fma_f32 v22, -v21, v19, v47
    v_fma_f32 v47, v22, v20, v21
    v_sub_f32 v48, v48, v17
    v_cvt_pk_bf16_f32 v48, v48, v48
    v_lshlrev_b32 v48, 16, v48
    v_mul_f32 v21, v48, v20
    v_fma_f32 v22, -v21, v19, v48
    v_fma_f32 v48, v22, v20, v21
    v_sub_f32 v49, v49, v17
    v_cvt_pk_bf16_f32 v49, v49, v49
    v_lshlrev_b32 v49, 16, v49
    v_mul_f32 v21, v49, v20
    v_fma_f32 v22, -v21, v19, v49
    v_fma_f32 v49, v22, v20, v21
    v_sub_f32 v50, v50, v17
    v_cvt_pk_bf16_f32 v50, v50, v50
    v_lshlrev_b32 v50, 16, v50
    v_mul_f32 v21, v50, v20
    v_fma_f32 v22, -v21, v19, v50
    v_fma_f32 v50, v22, v20, v21
    v_sub_f32 v51, v51, v17
    v_cvt_pk_bf16_f32 v51, v51, v51
    v_lshlrev_b32 v51, 16, v51
    v_mul_f32 v21, v51, v20
    v_fma_f32 v22, -v21, v19, v51
    v_fma_f32 v51, v22, v20, v21
    v_cvt_pk_bf16_f32 v52, v36, v37
    v_cvt_pk_bf16_f32 v53, v38, v39
    v_cvt_pk_bf16_f32 v54, v40, v41
    v_cvt_pk_bf16_f32 v55, v42, v43
    v_cvt_pk_bf16_f32 v56, v44, v45
    v_cvt_pk_bf16_f32 v57, v46, v47
    v_cvt_pk_bf16_f32 v58, v48, v49
    v_cvt_pk_bf16_f32 v59, v50, v51
    s_waitcnt vmcnt(14)
    v_perm_b32 v16, v68, v64, s14
    v_perm_b32 v17, v68, v64, s15
    v_dot2_f32_bf16 v8, v16, v52, 0
    v_dot2_f32_bf16 v9, v17, v52, 0
    v_perm_b32 v18, v69, v65, s14
    v_perm_b32 v19, v69, v65, s15
    v_dot2_f32_bf16 v10, v18, v52, 0
    v_dot2_f32_bf16 v11, v19, v52, 0
    v_perm_b32 v16, v70, v66, s14
    v_perm_b32 v17, v70, v66, s15
    v_dot2_f32_bf16 v12, v16, v52, 0
    v_dot2_f32_bf16 v13, v17, v52, 0
    v_perm_b32 v18, v71, v67, s14
    v_perm_b32 v19, v71, v67, s15
    v_dot2_f32_bf16 v14, v18, v52, 0
    v_dot2_f32_bf16 v15, v19, v52, 0
    s_waitcnt vmcnt(12)
    v_perm_b32 v16, v76, v72, s14
    v_perm_b32 v17, v76, v72, s15
    v_dot2_f32_bf16 v8, v16, v53, v8
    v_dot2_f32_bf16 v9, v17, v53, v9
    v_perm_b32 v18, v77, v73, s14
    v_perm_b32 v19, v77, v73, s15
    v_dot2_f32_bf16 v10, v18, v53, v10
    v_dot2_f32_bf16 v11, v19, v53, v11
    v_perm_b32 v16, v78, v74, s14
    v_perm_b32 v17, v78, v74, s15
    v_dot2_f32_bf16 v12, v16, v53, v12
    v_dot2_f32_bf16 v13, v17, v53, v13
    v_perm_b32 v18, v79, v75, s14
    v_perm_b32 v19, v79, v75, s15
    v_dot2_f32_bf16 v14, v18, v53, v14
    v_dot2_f32_bf16 v15, v19, v53, v15
    s_waitcnt vmcnt(10)
    v_perm_b32 v16, v84, v80, s14
    v_perm_b32 v17, v84, v80, s15
    v_dot2_f32_bf16 v8, v16, v54, v8
    v_dot2_f32_bf16 v9, v17, v54, v9
    v_perm_b32 v18, v85, v81, s14
    v_perm_b32 v19, v85, v81, s15
    v_dot2_f32_bf16 v10, v18, v54, v10
    v_dot2_f32_bf16 v11, v19, v54, v11
    v_perm_b32 v16, v86, v82, s14
    v_perm_b32 v17, v86, v82, s15
    v_dot2_f32_bf16 v12, v16, v54, v12
    v_dot2_f32_bf16 v13, v17, v54, v13
    v_perm_b32 v18, v87, v83, s14
    v_perm_b32 v19, v87, v83, s15
    v_dot2_f32_bf16 v14, v18, v54, v14
    v_dot2_f32_bf16 v15, v19, v54, v15
    s_waitcnt vmcnt(8)
    v_perm_b32 v16, v92, v88, s14
    v_perm_b32 v17, v92, v88, s15
    v_dot2_f32_bf16 v8, v16, v55, v8
    v_dot2_f32_bf16 v9, v17, v55, v9
    v_perm_b32 v18, v93, v89, s14
    v_perm_b32 v19, v93, v89, s15
    v_dot2_f32_bf16 v10, v18, v55, v10
    v_dot2_f32_bf16 v11, v19, v55, v11
    v_perm_b32 v16, v94, v90, s14
    v_perm_b32 v17, v94, v90, s15
    v_dot2_f32_bf16 v12, v16, v55, v12
    v_dot2_f32_bf16 v13, v17, v55, v13
    v_perm_b32 v18, v95, v91, s14
    v_perm_b32 v19, v95, v91, s15
    v_dot2_f32_bf16 v14, v18, v55, v14
    v_dot2_f32_bf16 v15, v19, v55, v15
    s_waitcnt vmcnt(6)
    v_perm_b32 v16, v100, v96, s14
    v_perm_b32 v17, v100, v96, s15
    v_dot2_f32_bf16 v8, v16, v56, v8
    v_dot2_f32_bf16 v9, v17, v56, v9
    v_perm_b32 v18, v101, v97, s14
    v_perm_b32 v19, v101, v97, s15
    v_dot2_f32_bf16 v10, v18, v56, v10
    v_dot2_f32_bf16 v11, v19, v56, v11
    v_perm_b32 v16, v102, v98, s14
    v_perm_b32 v17, v102, v98, s15
    v_dot2_f32_bf16 v12, v16, v56, v12
    v_dot2_f32_bf16 v13, v17, v56, v13
    v_perm_b32 v18, v103, v99, s14
    v_perm_b32 v19, v103, v99, s15
    v_dot2_f32_bf16 v14, v18, v56, v14
    v_dot2_f32_bf16 v15, v19, v56, v15
    s_waitcnt vmcnt(4)
    v_perm_b32 v16, v108, v104, s14
    v_perm_b32 v17, v108, v104, s15
    v_dot2_f32_bf16 v8, v16, v57, v8
    v_dot2_f32_bf16 v9, v17, v57, v9
    v_perm_b32 v18, v109, v105, s14
    v_perm_b32 v19, v109, v105, s15
    v_dot2_f32_bf16 v10, v18, v57, v10
    v_dot2_f32_bf16 v11, v19, v57, v11
    v_perm_b32 v16, v110, v106, s14
    v_perm_b32 v17, v110, v106, s15
    v_dot2_f32_bf16 v12, v16, v57, v12
    v_dot2_f32_bf16 v13, v17, v57, v13
    v_perm_b32 v18, v111, v107, s14
    v_perm_b32 v19, v111, v107, s15
    v_dot2_f32_bf16 v14, v18, v57, v14
    v_dot2_f32_bf16 v15, v19, v57, v15
    s_waitcnt vmcnt(2)
    v_perm_b32 v16, v116, v112, s14
    v_perm_b32 v17, v116, v112, s15
    v_dot2_f32_bf16 v8, v16, v58, v8
    v_dot2_f32_bf16 v9, v17, v58, v9
    v_perm_b32 v18, v117, v113, s14
    v_perm_b32 v19, v117, v113, s15
    v_dot2_f32_bf16 v10, v18, v58, v10
    v_dot2_f32_bf16 v11, v19, v58, v11
    v_perm_b32 v16, v118, v114, s14
    v_perm_b32 v17, v118, v114, s15
    v_dot2_f32_bf16 v12, v16, v58, v12
    v_dot2_f32_bf16 v13, v17, v58, v13
    v_perm_b32 v18, v119, v115, s14
    v_perm_b32 v19, v119, v115, s15
    v_dot2_f32_bf16 v14, v18, v58, v14
    v_dot2_f32_bf16 v15, v19, v58, v15
    s_waitcnt vmcnt(0)
    v_perm_b32 v16, v124, v120, s14
    v_perm_b32 v17, v124, v120, s15
    v_dot2_f32_bf16 v8, v16, v59, v8
    v_dot2_f32_bf16 v9, v17, v59, v9
    v_perm_b32 v18, v125, v121, s14
    v_perm_b32 v19, v125, v121, s15
    v_dot2_f32_bf16 v10, v18, v59, v10
    v_dot2_f32_bf16 v11, v19, v59, v11
    v_perm_b32 v16, v126, v122, s14
    v_perm_b32 v17, v126, v122, s15
    v_dot2_f32_bf16 v12, v16, v59, v12
    v_dot2_f32_bf16 v13, v17, v59, v13
    v_perm_b32 v18, v127, v123, s14
    v_perm_b32 v19, v127, v123, s15
    v_dot2_f32_bf16 v14, v18, v59, v14
    v_dot2_f32_bf16 v15, v19, v59, v15
    v_permlane32_swap_b32 v8, v12
    v_permlane32_swap_b32 v9, v13
    v_permlane32_swap_b32 v10, v14
    v_permlane32_swap_b32 v11, v15
    v_add_f32 v8, v8, v12
    v_add_f32 v9, v9, v13
    v_add_f32 v10, v10, v14
    v_add_f32 v11, v11, v15
    s_nop 0
    v_permlane16_swap_b32 v8, v10
    v_permlane16_swap_b32 v9, v11
    v_add_f32 v20, v8, v10
    v_add_f32 v21, v9, v11
    v_lshlrev_b32 v22, 1, v3
    v_lshl_add_u32 v22, v2, 3, v22
    s_lshl_b32 s54, s9, 9
    v_add_u32 v22, s54, v22
    ds_write_b64 v22, v[20:21] offset:0
    s_waitcnt lgkmcnt(0)
    v_mov_b32 v22, 0
    v_mov_b32 v23, 1
    s_mov_b64 exec, 1
    ds_add_u32 v22, v23 offset:4432
    s_mov_b64 exec, -1
    s_cmp_lt_u32 s3, 10
    s_cbranch_scc0 L_q_skip
    v_mov_b32 v22, 0
L_wait_qp_17:
    ds_read_b32 v23, v22 offset:4432
    s_waitcnt lgkmcnt(0)
    v_readfirstlane_b32 s57, v23
    s_cmp_lt_u32 s57, 8
    s_cbranch_scc1 L_wait_qp_17
    v_and_b32 v23, 127, v0
    v_lshlrev_b32 v22, 2, v23
    ds_read_b32 v32, v22 offset:0
    ds_read_b32 v33, v22 offset:512
    ds_read_b32 v34, v22 offset:1024
    ds_read_b32 v35, v22 offset:1536
    ds_read_b32 v36, v22 offset:2048
    ds_read_b32 v37, v22 offset:2560
    ds_read_b32 v38, v22 offset:3072
    ds_read_b32 v39, v22 offset:3584
    s_waitcnt lgkmcnt(0)
    v_add_f32 v32, v32, v33
    v_add_f32 v34, v34, v35
    v_add_f32 v36, v36, v37
    v_add_f32 v38, v38, v39
    v_add_f32 v32, v32, v34
    v_add_f32 v36, v36, v38
    v_add_f32 v32, v32, v36
    v_mov_b32 v8, v32
    v_cvt_pk_bf16_f32 v8, v8, v8
    v_lshlrev_b32 v22, 1, v23
    ds_write_b16 v22, v8 offset:4096
    s_waitcnt lgkmcnt(0)
    v_mov_b32 v22, 0
    v_mov_b32 v23, 1
    s_mov_b64 exec, 1
    ds_add_u32 v22, v23 offset:4436
    s_mov_b64 exec, -1
L_q_skip:
    v_mov_b32 v22, 0
L_wait_k_18:
    ds_read_b32 v23, v22 offset:4440
    s_waitcnt lgkmcnt(0)
    v_readfirstlane_b32 s57, v23
    s_cmp_lt_u32 s57, 8
    s_cbranch_scc1 L_wait_k_18
    global_load_dwordx4 v[64:67], v4, s[42:43] nt
    global_load_dwordx4 v[68:71], v4, s[42:43] offset:256 nt
    global_load_dwordx4 v[72:75], v4, s[42:43] offset:512 nt
    global_load_dwordx4 v[76:79], v4, s[42:43] offset:768 nt
    global_load_dwordx4 v[80:83], v4, s[42:43] offset:1024 nt
    global_load_dwordx4 v[84:87], v4, s[42:43] offset:1280 nt
    global_load_dwordx4 v[88:91], v4, s[42:43] offset:1536 nt
    global_load_dwordx4 v[92:95], v4, s[42:43] offset:1792 nt
    global_load_dwordx4 v[96:99], v4, s[42:43] offset:2048 nt
    global_load_dwordx4 v[100:103], v4, s[42:43] offset:2304 nt
    global_load_dwordx4 v[104:107], v4, s[42:43] offset:2560 nt
    global_load_dwordx4 v[108:111], v4, s[42:43] offset:2816 nt
    global_load_dwordx4 v[112:115], v4, s[42:43] offset:3072 nt
    global_load_dwordx4 v[116:119], v4, s[42:43] offset:3328 nt
    global_load_dwordx4 v[120:123], v4, s[42:43] offset:3584 nt
    global_load_dwordx4 v[124:127], v4, s[42:43] offset:3840 nt
    v_mov_b32 v22, 0
L_wait_p_19:
    ds_read_b32 v23, v22 offset:4452
    s_waitcnt lgkmcnt(0)
    v_readfirstlane_b32 s57, v23
    s_cmp_lt_u32 s57, 8
    s_cbranch_scc1 L_wait_p_19
    s_setprio 3
    s_lshl_b32 s54, s9, 7
    v_lshl_add_u32 v22, v2, 5, s54
    ds_read_b128 v[8:11], v22 offset:4480
    ds_read_b128 v[12:15], v22 offset:4496
    s_waitcnt lgkmcnt(0)
    s_waitcnt vmcnt(14)
    v_perm_b32 v16, v68, v64, s14
    v_perm_b32 v17, v68, v64, s15
    v_dot2_f32_bf16 v32, v16, v8, 0
    v_dot2_f32_bf16 v33, v17, v8, 0
    v_perm_b32 v18, v69, v65, s14
    v_perm_b32 v19, v69, v65, s15
    v_dot2_f32_bf16 v34, v18, v8, 0
    v_dot2_f32_bf16 v35, v19, v8, 0
    v_perm_b32 v16, v70, v66, s14
    v_perm_b32 v17, v70, v66, s15
    v_dot2_f32_bf16 v36, v16, v8, 0
    v_dot2_f32_bf16 v37, v17, v8, 0
    v_perm_b32 v18, v71, v67, s14
    v_perm_b32 v19, v71, v67, s15
    v_dot2_f32_bf16 v38, v18, v8, 0
    v_dot2_f32_bf16 v39, v19, v8, 0
    s_waitcnt vmcnt(12)
    v_perm_b32 v16, v76, v72, s14
    v_perm_b32 v17, v76, v72, s15
    v_dot2_f32_bf16 v32, v16, v9, v32
    v_dot2_f32_bf16 v33, v17, v9, v33
    v_perm_b32 v18, v77, v73, s14
    v_perm_b32 v19, v77, v73, s15
    v_dot2_f32_bf16 v34, v18, v9, v34
    v_dot2_f32_bf16 v35, v19, v9, v35
    v_perm_b32 v16, v78, v74, s14
    v_perm_b32 v17, v78, v74, s15
    v_dot2_f32_bf16 v36, v16, v9, v36
    v_dot2_f32_bf16 v37, v17, v9, v37
    v_perm_b32 v18, v79, v75, s14
    v_perm_b32 v19, v79, v75, s15
    v_dot2_f32_bf16 v38, v18, v9, v38
    v_dot2_f32_bf16 v39, v19, v9, v39
    s_waitcnt vmcnt(10)
    v_perm_b32 v16, v84, v80, s14
    v_perm_b32 v17, v84, v80, s15
    v_dot2_f32_bf16 v32, v16, v10, v32
    v_dot2_f32_bf16 v33, v17, v10, v33
    v_perm_b32 v18, v85, v81, s14
    v_perm_b32 v19, v85, v81, s15
    v_dot2_f32_bf16 v34, v18, v10, v34
    v_dot2_f32_bf16 v35, v19, v10, v35
    v_perm_b32 v16, v86, v82, s14
    v_perm_b32 v17, v86, v82, s15
    v_dot2_f32_bf16 v36, v16, v10, v36
    v_dot2_f32_bf16 v37, v17, v10, v37
    v_perm_b32 v18, v87, v83, s14
    v_perm_b32 v19, v87, v83, s15
    v_dot2_f32_bf16 v38, v18, v10, v38
    v_dot2_f32_bf16 v39, v19, v10, v39
    s_waitcnt vmcnt(8)
    v_perm_b32 v16, v92, v88, s14
    v_perm_b32 v17, v92, v88, s15
    v_dot2_f32_bf16 v32, v16, v11, v32
    v_dot2_f32_bf16 v33, v17, v11, v33
    v_perm_b32 v18, v93, v89, s14
    v_perm_b32 v19, v93, v89, s15
    v_dot2_f32_bf16 v34, v18, v11, v34
    v_dot2_f32_bf16 v35, v19, v11, v35
    v_perm_b32 v16, v94, v90, s14
    v_perm_b32 v17, v94, v90, s15
    v_dot2_f32_bf16 v36, v16, v11, v36
    v_dot2_f32_bf16 v37, v17, v11, v37
    v_perm_b32 v18, v95, v91, s14
    v_perm_b32 v19, v95, v91, s15
    v_dot2_f32_bf16 v38, v18, v11, v38
    v_dot2_f32_bf16 v39, v19, v11, v39
    s_waitcnt vmcnt(6)
    v_perm_b32 v16, v100, v96, s14
    v_perm_b32 v17, v100, v96, s15
    v_dot2_f32_bf16 v32, v16, v12, v32
    v_dot2_f32_bf16 v33, v17, v12, v33
    v_perm_b32 v18, v101, v97, s14
    v_perm_b32 v19, v101, v97, s15
    v_dot2_f32_bf16 v34, v18, v12, v34
    v_dot2_f32_bf16 v35, v19, v12, v35
    v_perm_b32 v16, v102, v98, s14
    v_perm_b32 v17, v102, v98, s15
    v_dot2_f32_bf16 v36, v16, v12, v36
    v_dot2_f32_bf16 v37, v17, v12, v37
    v_perm_b32 v18, v103, v99, s14
    v_perm_b32 v19, v103, v99, s15
    v_dot2_f32_bf16 v38, v18, v12, v38
    v_dot2_f32_bf16 v39, v19, v12, v39
    s_waitcnt vmcnt(4)
    v_perm_b32 v16, v108, v104, s14
    v_perm_b32 v17, v108, v104, s15
    v_dot2_f32_bf16 v32, v16, v13, v32
    v_dot2_f32_bf16 v33, v17, v13, v33
    v_perm_b32 v18, v109, v105, s14
    v_perm_b32 v19, v109, v105, s15
    v_dot2_f32_bf16 v34, v18, v13, v34
    v_dot2_f32_bf16 v35, v19, v13, v35
    v_perm_b32 v16, v110, v106, s14
    v_perm_b32 v17, v110, v106, s15
    v_dot2_f32_bf16 v36, v16, v13, v36
    v_dot2_f32_bf16 v37, v17, v13, v37
    v_perm_b32 v18, v111, v107, s14
    v_perm_b32 v19, v111, v107, s15
    v_dot2_f32_bf16 v38, v18, v13, v38
    v_dot2_f32_bf16 v39, v19, v13, v39
    s_waitcnt vmcnt(2)
    v_perm_b32 v16, v116, v112, s14
    v_perm_b32 v17, v116, v112, s15
    v_dot2_f32_bf16 v32, v16, v14, v32
    v_dot2_f32_bf16 v33, v17, v14, v33
    v_perm_b32 v18, v117, v113, s14
    v_perm_b32 v19, v117, v113, s15
    v_dot2_f32_bf16 v34, v18, v14, v34
    v_dot2_f32_bf16 v35, v19, v14, v35
    v_perm_b32 v16, v118, v114, s14
    v_perm_b32 v17, v118, v114, s15
    v_dot2_f32_bf16 v36, v16, v14, v36
    v_dot2_f32_bf16 v37, v17, v14, v37
    v_perm_b32 v18, v119, v115, s14
    v_perm_b32 v19, v119, v115, s15
    v_dot2_f32_bf16 v38, v18, v14, v38
    v_dot2_f32_bf16 v39, v19, v14, v39
    s_waitcnt vmcnt(0)
    v_perm_b32 v16, v124, v120, s14
    v_perm_b32 v17, v124, v120, s15
    v_dot2_f32_bf16 v32, v16, v15, v32
    v_dot2_f32_bf16 v33, v17, v15, v33
    v_perm_b32 v18, v125, v121, s14
    v_perm_b32 v19, v125, v121, s15
    v_dot2_f32_bf16 v34, v18, v15, v34
    v_dot2_f32_bf16 v35, v19, v15, v35
    v_perm_b32 v16, v126, v122, s14
    v_perm_b32 v17, v126, v122, s15
    v_dot2_f32_bf16 v36, v16, v15, v36
    v_dot2_f32_bf16 v37, v17, v15, v37
    v_perm_b32 v18, v127, v123, s14
    v_perm_b32 v19, v127, v123, s15
    v_dot2_f32_bf16 v38, v18, v15, v38
    v_dot2_f32_bf16 v39, v19, v15, v39
    v_permlane32_swap_b32 v32, v36
    v_permlane32_swap_b32 v33, v37
    v_permlane32_swap_b32 v34, v38
    v_permlane32_swap_b32 v35, v39
    v_add_f32 v32, v32, v36
    v_add_f32 v33, v33, v37
    v_add_f32 v34, v34, v38
    v_add_f32 v35, v35, v39
    s_nop 0
    v_permlane16_swap_b32 v32, v34
    v_permlane16_swap_b32 v33, v35
    v_add_f32 v20, v32, v34
    v_add_f32 v21, v33, v35
    v_lshlrev_b32 v22, 1, v3
    v_lshl_add_u32 v22, v2, 3, v22
    s_lshl_b32 s54, s9, 9
    v_add_u32 v22, s54, v22
    ds_write_b64 v22, v[20:21] offset:5504
    s_waitcnt lgkmcnt(0)
    s_barrier
    s_cmp_ge_u32 s2, 43
    s_cbranch_scc1 L_end
    v_and_b32 v5, 511, v0
    v_lshrrev_b32 v6, 2, v5
    v_mul_u32_u24 v6, 2752, v6
    v_and_b32 v7, 3, v5
    v_lshl_add_u32 v6, v7, 4, v6
    s_lshl_b32 s54, s2, 6
    s_add_u32 s74, s28, s54
    s_addc_u32 s75, s29, 0
    global_load_dwordx4 v[8:11], v6, s[74:75] nt
    s_add_u32 s12, s74, 352256
    s_addc_u32 s13, s75, 0
    global_load_dwordx4 v[12:15], v6, s[12:13] nt
    s_add_u32 s12, s74, 704512
    s_addc_u32 s13, s75, 0
    global_load_dwordx4 v[16:19], v6, s[12:13] nt
    s_add_u32 s12, s74, 1056768
    s_addc_u32 s13, s75, 0
    global_load_dwordx4 v[20:23], v6, s[12:13] nt
    v_lshlrev_b32 v6, 4, v5
    s_lshl_b32 s54, s2, 15
    s_add_u32 s74, s32, s54
    s_addc_u32 s75, s33, 0
    global_load_dwordx4 v[24:27], v6, s[74:75] nt
    s_add_u32 s12, s74, 8192
    s_addc_u32 s13, s75, 0
    global_load_dwordx4 v[28:31], v6, s[12:13] nt
    s_add_u32 s12, s74, 16384
    s_addc_u32 s13, s75, 0
    global_load_dwordx4 v[32:35], v6, s[12:13] nt
    s_add_u32 s12, s74, 24576
    s_addc_u32 s13, s75, 0
    global_load_dwordx4 v[36:39], v6, s[12:13] nt
    v_add_u32 v7, 62976, v6
    s_waitcnt vmcnt(4)
    ds_write_b128 v6, v[8:11] offset:30208
    ds_write_b128 v6, v[12:15] offset:38400
    ds_write_b128 v6, v[16:19] offset:46592
    ds_write_b128 v6, v[20:23] offset:54784
    s_waitcnt vmcnt(0)
    ds_write_b128 v7, v[24:27] offset:0
    ds_write_b128 v7, v[28:31] offset:8192
    ds_write_b128 v7, v[32:35] offset:16384
    ds_write_b128 v7, v[36:39] offset:24576
    s_waitcnt lgkmcnt(0)
    v_mov_b32 v22, 0
    v_mov_b32 v23, 1
    s_mov_b64 exec, 1
    ds_add_u32 v22, v23 offset:4456
    s_mov_b64 exec, -1
    s_waitcnt lgkmcnt(0)
L_end:
L_end2:
    s_endpgm

.section .rodata,"a"
.p2align 6
.amdhsa_kernel sequential_preLN__sliding_block_cached__dense_activation_squared_relu__decode_kernel
  .amdhsa_next_free_vgpr 128
  .amdhsa_next_free_sgpr 102
  .amdhsa_accum_offset 128
  .amdhsa_group_segment_fixed_size 0
  .amdhsa_kernarg_size 104
  .amdhsa_user_sgpr_count 2
  .amdhsa_user_sgpr_kernarg_segment_ptr 1
  .amdhsa_system_sgpr_workgroup_id_x 1
  .amdhsa_float_denorm_mode_32 3
  .amdhsa_float_denorm_mode_16_64 3
.end_amdhsa_kernel
```
